```python
import torch

def _softmax(x, axis=-1):
    return torch.softmax(x, dim=axis)
def _gelu(x):
    return torch.nn.functional.gelu(x, approximate="tanh")
def _silu(x):
    return torch.nn.functional.silu(x)
def _sigmoid(x):
    return torch.sigmoid(x)
def _layernorm(x, axis=-1, eps=1e-5):
    m = x.mean(dim=axis, keepdim=True)
    v = x.var(dim=axis, keepdim=True, unbiased=False)
    return (x - m) / torch.sqrt(v + eps)
def _scatter_add(tgt, idx, src, axis=0):
    return tgt.clone().index_add_(axis, idx, src)
def _segment_sum(src, seg, n):
    out = torch.zeros((n,) + src.shape[1:], dtype=src.dtype)
    return out.index_add_(0, seg, src)
def _pad(x, pw):
    flat = tuple(v for pair in reversed(pw) for v in pair)
    return torch.nn.functional.pad(x, flat)

kernel_name = 'parallel_sum__ssm_conv_s4d__dense_activation_mish__prompt'

def setup_inputs():

    _w = (lambda a: (lambda t: t.to(torch.bfloat16) if t.is_floating_point() else t)(torch.as_tensor(a)))
    def _A_setup():
        Bsz, L, D, N = 1, 2048, 640, 128
        return {
            "u": _w((lambda *s: torch.randn(*s, dtype=torch.bfloat16) * 0.05)(Bsz, L, D)),
            "log_A_real": _w((lambda *s: torch.randn(*s, dtype=torch.bfloat16) * 3.2)(D, N) * 0.5),
            "A_imag": _w((lambda *s: torch.randn(*s, dtype=torch.bfloat16) * 0.05)(D, N) * 3.14),
            "C_real": _w((lambda *s: torch.randn(*s, dtype=torch.bfloat16) * 0.2)(D, N) / N ** 0.5),
            "C_imag": _w((lambda *s: torch.randn(*s, dtype=torch.bfloat16) * 0.2)(D, N) / N ** 0.5),
            "log_dt": _w((lambda *s: torch.randn(*s, dtype=torch.bfloat16) * 0.05)(D) * 0.5 - 4.0),
            "D_skip": _w((lambda *s: torch.randn(*s, dtype=torch.bfloat16) * 0.05)(D)),
        }
    _A_in = _A_setup()

    def _B_setup():
        B, S, D, F = 1, 2048, 640, 1728
        return {
            "x": _w((lambda *s: torch.randn(*s, dtype=torch.bfloat16) * 0.05)(B, S, D)),
            "w1": _w((lambda *s: torch.randn(*s, dtype=torch.bfloat16) * 0.8)(D, F) * (D ** -0.5)),
            "b1": _w((lambda *s: torch.randn(*s, dtype=torch.bfloat16) * 0.2)(F)),
            "w2": _w((lambda *s: torch.randn(*s, dtype=torch.bfloat16) * 0.2)(F, D) * (F ** -0.5)),
        }
    _B_in = _B_setup()

    return {
        "A_u": _A_in["u"],
        "A_log_A_real": _A_in["log_A_real"],
        "A_A_imag": _A_in["A_imag"],
        "A_C_real": _A_in["C_real"],
        "A_C_imag": _A_in["C_imag"],
        "A_log_dt": _A_in["log_dt"],
        "A_D_skip": _A_in["D_skip"],
        "B_x": _B_in["x"],
        "B_w1": _B_in["w1"],
        "B_b1": _B_in["b1"],
        "B_w2": _B_in["w2"],
    }

def reference(A_u, A_log_A_real, A_A_imag, A_C_real, A_C_imag, A_log_dt, A_D_skip, B_x, B_w1, B_b1, B_w2):
    def _A_ref(u, log_A_real, A_imag, C_real, C_imag, log_dt, D_skip):
        L = u.shape[1]
        dt = torch.exp(log_dt)
        A = -torch.exp(log_A_real) + 1j * A_imag
        C = (C_real + 1j * C_imag) * dt[:, None]
        pos = (lambda x, dt: x.to(dt))(torch.arange(L), log_dt.dtype)
        P = torch.exp((A * dt[:, None])[:, :, None] * pos[None, None, :])
        K = 2.0 * torch.einsum("dn,dnl->dl", C, P).real
        L2 = 2 * L
        u_t = (lambda x, *d: x.permute(*d))(u, 0, 2, 1)
        Kf = (lambda x, *a, **k: torch.fft.rfft(x.float(), *a, **k))(K, L2)
        Uf = (lambda x, *a, **k: torch.fft.rfft(x.float(), *a, **k))(u_t, L2)
        y = (lambda x, *a, **k: torch.fft.irfft(x, *a, **k).to(torch.bfloat16))(Uf * Kf[None, :, :], L2)[:, :, :L]
        y = (lambda x, *d: x.permute(*d))(y, 0, 2, 1)
        return y + u * D_skip[None, None, :]

    def _B_ref(x, w1, b1, w2):
        h = torch.einsum("bsd,df->bsf", x, w1) + b1
        sp = torch.log1p(torch.exp(-torch.abs(h))) + torch.where(h > 0, h, torch.zeros_like(h))
        act = h * torch.tanh(sp)
        return torch.einsum("bsf,fd->bsd", act, w2)

    x = A_u
    xn = _layernorm(x, axis=-1)
    return x + _A_ref(xn, A_log_A_real, A_A_imag, A_C_real, A_C_imag, A_log_dt, A_D_skip) + _B_ref(xn, B_w1, B_b1, B_w2)
```

```asm
; @launch kernel=prep_kernel grid=(919,1,1) block=(256,1,1) lds=37440
; @launch kernel=mid_kernel grid=(896,1,1) block=(256,1,1) lds=40960
; @launch kernel=fin_kernel grid=(256,1,1) block=(256,1,1) lds=51200
.amdgcn_target "amdgcn-amd-amdhsa--gfx950"
.text
.globl prep_kernel
.p2align 8
.type prep_kernel,@function
prep_kernel:
    s_cmp_ge_u32 s2, 919
    s_cbranch_scc1 L_end_p1
    s_load_dwordx16 s[8:23], s[0:1], 0
    s_load_dwordx8 s[24:31], s[0:1], 64
    s_load_dwordx4 s[32:35], s[0:1], 96
    v_lshrrev_b32 v1, 6, v0
    v_and_b32 v0, 63, v0
    s_nop 0
    v_readfirstlane_b32 s3, v1
    s_waitcnt lgkmcnt(0)
    s_mov_b32 s36, s34
    s_and_b32 s37, s35, 0xffff
    s_mov_b32 s38, 25141248
    s_mov_b32 s39, 0x00020000
    s_lshr_b32 s5, s2, 7
    s_cmp_eq_u32 s5, 0
    s_cbranch_scc1 L_p1_ln
    s_sub_u32 s4, s2, 128
    s_cmp_eq_u32 s5, 1
    s_cbranch_scc1 L_p1_kg
    s_sub_u32 s4, s2, 256
    s_cmp_eq_u32 s5, 2
    s_cbranch_scc1 L_p1_wt
    s_cmp_lt_u32 s5, 7
    s_cbranch_scc1 L_p1_kg
    s_sub_u32 s4, s2, 768
    s_cmp_lt_u32 s2, 903
    s_cbranch_scc1 L_p1_wt
    s_getpc_b64 s[60:61]
L_pc_1:
    s_add_u32 s60, s60, mid_kernel-L_pc_1
    s_addc_u32 s61, s61, 0
    s_lshl_b32 s62, s3, 13
    v_lshl_add_u32 v120, v0, 7, s62
    v_min_u32 v120, L_end_p3-mid_kernel-64, v120
    global_load_dword v121, v120, s[60:61]
    global_load_dword v122, v120, s[60:61] offset:64
    s_waitcnt vmcnt(0)
    s_branch L_end_p1
L_p1_wt:
    s_lshl_b32 s4, s4, 2
    s_add_u32 s4, s4, s3
    s_mov_b32 s5, 3456
    s_mov_b32 s42, 2428
    s_mov_b32 s43, 20480
    s_mov_b32 s48, 5406720
    s_cmp_ge_u32 s4, 270
    s_cselect_b32 s44, s28, s24
    s_cselect_b32 s45, s29, s25
    s_cselect_b32 s5, 1280, s5
    s_cselect_b32 s6, 270, 0
    s_cselect_b32 s7, 10, 27
    s_cselect_b32 s42, 6554, s42
    s_cselect_b32 s43, 55296, s43
    s_cselect_b32 s48, 7618560, s48
    s_and_b32 s45, s45, 0xffff
    s_mov_b32 s46, 2211840
    s_mov_b32 s47, 0x00020000
    s_sub_u32 s4, s4, s6
    s_mul_i32 s49, s4, s42
    s_lshr_b32 s49, s49, 16
    s_mul_i32 s50, s49, s7
    s_sub_u32 s50, s4, s50
    s_lshl_b32 s6, s5, 3
    v_lshrrev_b32 v1, 3, v0
    v_mul_u32_u24 v1, s6, v1
    v_and_b32 v2, 7, v0
    v_lshl_add_u32 v1, v2, 4, v1
    s_lshl_b32 s6, s6, 3
    s_mul_i32 s51, s49, s6
    s_lshl_b32 s6, s50, 7
    s_add_u32 s51, s51, s6
    buffer_load_dwordx4 v[40:43], v1, s[44:47], s51 offen
    s_add_u32 s51, s51, s5
    buffer_load_dwordx4 v[44:47], v1, s[44:47], s51 offen
    s_add_u32 s51, s51, s5
    buffer_load_dwordx4 v[48:51], v1, s[44:47], s51 offen
    s_add_u32 s51, s51, s5
    buffer_load_dwordx4 v[52:55], v1, s[44:47], s51 offen
    s_add_u32 s51, s51, s5
    buffer_load_dwordx4 v[56:59], v1, s[44:47], s51 offen
    s_add_u32 s51, s51, s5
    buffer_load_dwordx4 v[60:63], v1, s[44:47], s51 offen
    s_add_u32 s51, s51, s5
    buffer_load_dwordx4 v[64:67], v1, s[44:47], s51 offen
    s_add_u32 s51, s51, s5
    buffer_load_dwordx4 v[68:71], v1, s[44:47], s51 offen
    s_mul_i32 s6, s3, 9216
    v_mul_u32_u24 v2, 144, v0
    v_add_u32 v2, s6, v2
    v_lshrrev_b32 v3, 4, v0
    v_mul_u32_u24 v3, 1152, v3
    v_bfe_u32 v4, v0, 3, 1
    v_mul_u32_u24 v4, 144, v4
    v_add3_u32 v3, v3, v4, s6
    v_and_b32 v4, 7, v0
    v_lshl_add_u32 v3, v4, 4, v3
    v_lshlrev_b32 v4, 4, v0
    s_mul_i32 s52, s50, s43
    s_lshl_b32 s52, s52, 2
    s_lshl_b32 s6, s49, 11
    s_add_u32 s52, s52, s6
    s_add_u32 s52, s52, s48
    s_mov_b32 s40, 0x05040100
    s_mov_b32 s41, 0x07060302
    s_waitcnt vmcnt(0)
    v_perm_b32 v80, v44, v40, s40
    v_perm_b32 v81, v52, v48, s40
    v_perm_b32 v82, v60, v56, s40
    v_perm_b32 v83, v68, v64, s40
    ds_write_b128 v2, v[80:83] offset:0
    v_perm_b32 v84, v44, v40, s41
    v_perm_b32 v85, v52, v48, s41
    v_perm_b32 v86, v60, v56, s41
    v_perm_b32 v87, v68, v64, s41
    ds_write_b128 v2, v[84:87] offset:16
    v_perm_b32 v88, v45, v41, s40
    v_perm_b32 v89, v53, v49, s40
    v_perm_b32 v90, v61, v57, s40
    v_perm_b32 v91, v69, v65, s40
    ds_write_b128 v2, v[88:91] offset:32
    v_perm_b32 v92, v45, v41, s41
    v_perm_b32 v93, v53, v49, s41
    v_perm_b32 v94, v61, v57, s41
    v_perm_b32 v95, v69, v65, s41
    ds_write_b128 v2, v[92:95] offset:48
    v_perm_b32 v96, v46, v42, s40
    v_perm_b32 v97, v54, v50, s40
    v_perm_b32 v98, v62, v58, s40
    v_perm_b32 v99, v70, v66, s40
    ds_write_b128 v2, v[96:99] offset:64
    v_perm_b32 v100, v46, v42, s41
    v_perm_b32 v101, v54, v50, s41
    v_perm_b32 v102, v62, v58, s41
    v_perm_b32 v103, v70, v66, s41
    ds_write_b128 v2, v[100:103] offset:80
    v_perm_b32 v104, v47, v43, s40
    v_perm_b32 v105, v55, v51, s40
    v_perm_b32 v106, v63, v59, s40
    v_perm_b32 v107, v71, v67, s40
    ds_write_b128 v2, v[104:107] offset:96
    v_perm_b32 v108, v47, v43, s41
    v_perm_b32 v109, v55, v51, s41
    v_perm_b32 v110, v63, v59, s41
    v_perm_b32 v111, v71, v67, s41
    ds_write_b128 v2, v[108:111] offset:112
    s_waitcnt lgkmcnt(0)
    ds_read_b128 v[40:43], v3 offset:0
    ds_read_b128 v[44:47], v3 offset:4608
    ds_read_b128 v[48:51], v3 offset:288
    ds_read_b128 v[52:55], v3 offset:4896
    ds_read_b128 v[56:59], v3 offset:576
    ds_read_b128 v[60:63], v3 offset:5184
    ds_read_b128 v[64:67], v3 offset:864
    ds_read_b128 v[68:71], v3 offset:5472
    s_waitcnt lgkmcnt(7)
    buffer_store_dwordx4 v[40:43], v4, s[36:39], s52 offen offset:0 sc0 sc1
    s_waitcnt lgkmcnt(6)
    buffer_store_dwordx4 v[44:47], v4, s[36:39], s52 offen offset:1024 sc0 sc1
    s_add_u32 s52, s52, s43
    s_waitcnt lgkmcnt(5)
    buffer_store_dwordx4 v[48:51], v4, s[36:39], s52 offen offset:0 sc0 sc1
    s_waitcnt lgkmcnt(4)
    buffer_store_dwordx4 v[52:55], v4, s[36:39], s52 offen offset:1024 sc0 sc1
    s_add_u32 s52, s52, s43
    s_waitcnt lgkmcnt(3)
    buffer_store_dwordx4 v[56:59], v4, s[36:39], s52 offen offset:0 sc0 sc1
    s_waitcnt lgkmcnt(2)
    buffer_store_dwordx4 v[60:63], v4, s[36:39], s52 offen offset:1024 sc0 sc1
    s_add_u32 s52, s52, s43
    s_waitcnt lgkmcnt(1)
    buffer_store_dwordx4 v[64:67], v4, s[36:39], s52 offen offset:0 sc0 sc1
    s_waitcnt lgkmcnt(0)
    buffer_store_dwordx4 v[68:71], v4, s[36:39], s52 offen offset:1024 sc0 sc1
    s_branch L_end_p1
L_p1_ln:
    s_sub_u32 s4, s2, 0
    s_lshl_b32 s5, s4, 4
    s_lshl_b32 s6, s3, 2
    s_add_u32 s5, s5, s6
    v_lshrrev_b32 v1, 4, v0
    v_and_b32 v2, 15, v0
    v_add_u32 v3, s5, v1
    v_mul_u32_u24 v3, 1280, v3
    v_lshl_add_u32 v3, v2, 4, v3
    global_load_dwordx4 v[10:13], v3, s[8:9] offset:0
    global_load_dwordx4 v[14:17], v3, s[8:9] offset:256
    global_load_dwordx4 v[18:21], v3, s[8:9] offset:512
    global_load_dwordx4 v[22:25], v3, s[8:9] offset:768
    global_load_dwordx4 v[26:29], v3, s[8:9] offset:1024
    v_add_u32 v116, s6, v1
    v_mul_u32_u24 v116, 1296, v116
    v_lshl_add_u32 v116, v2, 4, v116
    s_mul_i32 s5, s3, 320
    v_mul_u32_u24 v117, 1296, v2
    v_lshl_add_u32 v117, v1, 4, v117
    v_add_u32 v117, s5, v117
    v_lshlrev_b32 v118, 4, v0
    s_lshl_b32 s5, s3, 8
    v_lshl_add_u32 v119, v0, 2, s5
    s_lshl_b32 s5, s3, 12
    s_add_u32 s7, s5, 20736
    v_lshl_add_u32 v120, v0, 6, s7
    v_add_u32 v121, s7, v118
    s_mul_i32 s44, s4, 20480
    s_mul_i32 s40, s3, 5120
    s_add_u32 s40, s40, s44
    s_add_u32 s40, s40, 0
    s_add_u32 s41, s40, 4096
    s_add_u32 s45, s44, 2637824
    s_add_u32 s44, s44, s5
    s_add_u32 s44, s44, 2621440
    s_mov_b32 s46, 0x05040100
    s_mov_b32 s47, 0x07060302
    s_waitcnt vmcnt(0)
    v_lshlrev_b32 v40, 16, v10
    v_and_b32 v41, 0xffff0000, v10
    v_lshlrev_b32 v42, 16, v11
    v_and_b32 v43, 0xffff0000, v11
    v_lshlrev_b32 v44, 16, v12
    v_and_b32 v45, 0xffff0000, v12
    v_lshlrev_b32 v46, 16, v13
    v_and_b32 v47, 0xffff0000, v13
    v_lshlrev_b32 v48, 16, v14
    v_and_b32 v49, 0xffff0000, v14
    v_lshlrev_b32 v50, 16, v15
    v_and_b32 v51, 0xffff0000, v15
    v_lshlrev_b32 v52, 16, v16
    v_and_b32 v53, 0xffff0000, v16
    v_lshlrev_b32 v54, 16, v17
    v_and_b32 v55, 0xffff0000, v17
    v_lshlrev_b32 v56, 16, v18
    v_and_b32 v57, 0xffff0000, v18
    v_lshlrev_b32 v58, 16, v19
    v_and_b32 v59, 0xffff0000, v19
    v_lshlrev_b32 v60, 16, v20
    v_and_b32 v61, 0xffff0000, v20
    v_lshlrev_b32 v62, 16, v21
    v_and_b32 v63, 0xffff0000, v21
    v_lshlrev_b32 v64, 16, v22
    v_and_b32 v65, 0xffff0000, v22
    v_lshlrev_b32 v66, 16, v23
    v_and_b32 v67, 0xffff0000, v23
    v_lshlrev_b32 v68, 16, v24
    v_and_b32 v69, 0xffff0000, v24
    v_lshlrev_b32 v70, 16, v25
    v_and_b32 v71, 0xffff0000, v25
    v_lshlrev_b32 v72, 16, v26
    v_and_b32 v73, 0xffff0000, v26
    v_lshlrev_b32 v74, 16, v27
    v_and_b32 v75, 0xffff0000, v27
    v_lshlrev_b32 v76, 16, v28
    v_and_b32 v77, 0xffff0000, v28
    v_lshlrev_b32 v78, 16, v29
    v_and_b32 v79, 0xffff0000, v29
    v_pk_add_f32 v[80:81], v[40:41], v[44:45]
    v_pk_add_f32 v[82:83], v[42:43], v[46:47]
    v_pk_add_f32 v[80:81], v[80:81], v[48:49]
    v_pk_add_f32 v[82:83], v[82:83], v[50:51]
    v_pk_add_f32 v[80:81], v[80:81], v[52:53]
    v_pk_add_f32 v[82:83], v[82:83], v[54:55]
    v_pk_add_f32 v[80:81], v[80:81], v[56:57]
    v_pk_add_f32 v[82:83], v[82:83], v[58:59]
    v_pk_add_f32 v[80:81], v[80:81], v[60:61]
    v_pk_add_f32 v[82:83], v[82:83], v[62:63]
    v_pk_add_f32 v[80:81], v[80:81], v[64:65]
    v_pk_add_f32 v[82:83], v[82:83], v[66:67]
    v_pk_add_f32 v[80:81], v[80:81], v[68:69]
    v_pk_add_f32 v[82:83], v[82:83], v[70:71]
    v_pk_add_f32 v[80:81], v[80:81], v[72:73]
    v_pk_add_f32 v[82:83], v[82:83], v[74:75]
    v_pk_add_f32 v[80:81], v[80:81], v[76:77]
    v_pk_add_f32 v[82:83], v[82:83], v[78:79]
    v_pk_add_f32 v[80:81], v[80:81], v[82:83]
    v_add_f32 v4, v80, v81
    s_nop 1
    v_add_f32_dpp v4, v4, v4 row_ror:8 row_mask:0xf bank_mask:0xf
    s_nop 1
    v_add_f32_dpp v4, v4, v4 row_ror:4 row_mask:0xf bank_mask:0xf
    s_nop 1
    v_add_f32_dpp v4, v4, v4 row_ror:2 row_mask:0xf bank_mask:0xf
    s_nop 1
    v_add_f32_dpp v4, v4, v4 row_ror:1 row_mask:0xf bank_mask:0xf
    s_mov_b32 s7, 0x3acccccd
    v_mul_f32 v4, s7, v4
    v_pk_add_f32 v[84:85], v[40:41], v[4:5] op_sel_hi:[1,0] neg_lo:[0,1] neg_hi:[0,1]
    v_pk_add_f32 v[86:87], v[42:43], v[4:5] op_sel_hi:[1,0] neg_lo:[0,1] neg_hi:[0,1]
    v_pk_mul_f32 v[80:81], v[84:85], v[84:85]
    v_pk_mul_f32 v[82:83], v[86:87], v[86:87]
    v_pk_add_f32 v[84:85], v[44:45], v[4:5] op_sel_hi:[1,0] neg_lo:[0,1] neg_hi:[0,1]
    v_pk_add_f32 v[86:87], v[46:47], v[4:5] op_sel_hi:[1,0] neg_lo:[0,1] neg_hi:[0,1]
    v_pk_fma_f32 v[80:81], v[84:85], v[84:85], v[80:81]
    v_pk_fma_f32 v[82:83], v[86:87], v[86:87], v[82:83]
    v_pk_add_f32 v[84:85], v[48:49], v[4:5] op_sel_hi:[1,0] neg_lo:[0,1] neg_hi:[0,1]
    v_pk_add_f32 v[86:87], v[50:51], v[4:5] op_sel_hi:[1,0] neg_lo:[0,1] neg_hi:[0,1]
    v_pk_fma_f32 v[80:81], v[84:85], v[84:85], v[80:81]
    v_pk_fma_f32 v[82:83], v[86:87], v[86:87], v[82:83]
    v_pk_add_f32 v[84:85], v[52:53], v[4:5] op_sel_hi:[1,0] neg_lo:[0,1] neg_hi:[0,1]
    v_pk_add_f32 v[86:87], v[54:55], v[4:5] op_sel_hi:[1,0] neg_lo:[0,1] neg_hi:[0,1]
    v_pk_fma_f32 v[80:81], v[84:85], v[84:85], v[80:81]
    v_pk_fma_f32 v[82:83], v[86:87], v[86:87], v[82:83]
    v_pk_add_f32 v[84:85], v[56:57], v[4:5] op_sel_hi:[1,0] neg_lo:[0,1] neg_hi:[0,1]
    v_pk_add_f32 v[86:87], v[58:59], v[4:5] op_sel_hi:[1,0] neg_lo:[0,1] neg_hi:[0,1]
    v_pk_fma_f32 v[80:81], v[84:85], v[84:85], v[80:81]
    v_pk_fma_f32 v[82:83], v[86:87], v[86:87], v[82:83]
    v_pk_add_f32 v[84:85], v[60:61], v[4:5] op_sel_hi:[1,0] neg_lo:[0,1] neg_hi:[0,1]
    v_pk_add_f32 v[86:87], v[62:63], v[4:5] op_sel_hi:[1,0] neg_lo:[0,1] neg_hi:[0,1]
    v_pk_fma_f32 v[80:81], v[84:85], v[84:85], v[80:81]
    v_pk_fma_f32 v[82:83], v[86:87], v[86:87], v[82:83]
    v_pk_add_f32 v[84:85], v[64:65], v[4:5] op_sel_hi:[1,0] neg_lo:[0,1] neg_hi:[0,1]
    v_pk_add_f32 v[86:87], v[66:67], v[4:5] op_sel_hi:[1,0] neg_lo:[0,1] neg_hi:[0,1]
    v_pk_fma_f32 v[80:81], v[84:85], v[84:85], v[80:81]
    v_pk_fma_f32 v[82:83], v[86:87], v[86:87], v[82:83]
    v_pk_add_f32 v[84:85], v[68:69], v[4:5] op_sel_hi:[1,0] neg_lo:[0,1] neg_hi:[0,1]
    v_pk_add_f32 v[86:87], v[70:71], v[4:5] op_sel_hi:[1,0] neg_lo:[0,1] neg_hi:[0,1]
    v_pk_fma_f32 v[80:81], v[84:85], v[84:85], v[80:81]
    v_pk_fma_f32 v[82:83], v[86:87], v[86:87], v[82:83]
    v_pk_add_f32 v[84:85], v[72:73], v[4:5] op_sel_hi:[1,0] neg_lo:[0,1] neg_hi:[0,1]
    v_pk_add_f32 v[86:87], v[74:75], v[4:5] op_sel_hi:[1,0] neg_lo:[0,1] neg_hi:[0,1]
    v_pk_fma_f32 v[80:81], v[84:85], v[84:85], v[80:81]
    v_pk_fma_f32 v[82:83], v[86:87], v[86:87], v[82:83]
    v_pk_add_f32 v[84:85], v[76:77], v[4:5] op_sel_hi:[1,0] neg_lo:[0,1] neg_hi:[0,1]
    v_pk_add_f32 v[86:87], v[78:79], v[4:5] op_sel_hi:[1,0] neg_lo:[0,1] neg_hi:[0,1]
    v_pk_fma_f32 v[80:81], v[84:85], v[84:85], v[80:81]
    v_pk_fma_f32 v[82:83], v[86:87], v[86:87], v[82:83]
    v_pk_add_f32 v[80:81], v[80:81], v[82:83]
    v_add_f32 v6, v80, v81
    s_nop 1
    v_add_f32_dpp v6, v6, v6 row_ror:8 row_mask:0xf bank_mask:0xf
    s_nop 1
    v_add_f32_dpp v6, v6, v6 row_ror:4 row_mask:0xf bank_mask:0xf
    s_nop 1
    v_add_f32_dpp v6, v6, v6 row_ror:2 row_mask:0xf bank_mask:0xf
    s_nop 1
    v_add_f32_dpp v6, v6, v6 row_ror:1 row_mask:0xf bank_mask:0xf
    v_mul_f32 v6, s7, v6
    v_cvt_pk_bf16_f32 v4, v4, v4
    v_lshlrev_b32 v4, 16, v4
    v_cvt_pk_bf16_f32 v6, v6, v6
    v_lshlrev_b32 v6, 16, v6
    v_add_f32 v6, 0x3727c5ac, v6
    v_cvt_pk_bf16_f32 v6, v6, v6
    v_lshlrev_b32 v6, 16, v6
    v_sqrt_f32 v6, v6
    s_nop 0
    v_cvt_pk_bf16_f32 v6, v6, v6
    v_lshlrev_b32 v6, 16, v6
    v_rcp_f32 v8, v6
    s_nop 0
    v_pk_add_f32 v[40:41], v[40:41], v[4:5] op_sel_hi:[1,0] neg_lo:[0,1] neg_hi:[0,1]
    v_pk_add_f32 v[42:43], v[42:43], v[4:5] op_sel_hi:[1,0] neg_lo:[0,1] neg_hi:[0,1]
    v_cvt_pk_bf16_f32 v80, v40, v41
    v_cvt_pk_bf16_f32 v84, v42, v43
    v_lshlrev_b32 v40, 16, v80
    v_and_b32 v41, 0xffff0000, v80
    v_lshlrev_b32 v42, 16, v84
    v_and_b32 v43, 0xffff0000, v84
    v_pk_mul_f32 v[80:81], v[40:41], v[8:9] op_sel_hi:[1,0]
    v_pk_mul_f32 v[84:85], v[42:43], v[8:9] op_sel_hi:[1,0]
    v_pk_fma_f32 v[40:41], v[80:81], v[6:7], v[40:41] op_sel_hi:[1,0,1] neg_lo:[1,0,0] neg_hi:[1,0,0]
    v_pk_fma_f32 v[42:43], v[84:85], v[6:7], v[42:43] op_sel_hi:[1,0,1] neg_lo:[1,0,0] neg_hi:[1,0,0]
    v_pk_fma_f32 v[80:81], v[40:41], v[8:9], v[80:81] op_sel_hi:[1,0,1]
    v_pk_fma_f32 v[84:85], v[42:43], v[8:9], v[84:85] op_sel_hi:[1,0,1]
    v_cvt_pk_bf16_f32 v10, v80, v81
    v_cvt_pk_bf16_f32 v11, v84, v85
    v_pk_add_f32 v[44:45], v[44:45], v[4:5] op_sel_hi:[1,0] neg_lo:[0,1] neg_hi:[0,1]
    v_pk_add_f32 v[46:47], v[46:47], v[4:5] op_sel_hi:[1,0] neg_lo:[0,1] neg_hi:[0,1]
    v_cvt_pk_bf16_f32 v80, v44, v45
    v_cvt_pk_bf16_f32 v84, v46, v47
    v_lshlrev_b32 v44, 16, v80
    v_and_b32 v45, 0xffff0000, v80
    v_lshlrev_b32 v46, 16, v84
    v_and_b32 v47, 0xffff0000, v84
    v_pk_mul_f32 v[80:81], v[44:45], v[8:9] op_sel_hi:[1,0]
    v_pk_mul_f32 v[84:85], v[46:47], v[8:9] op_sel_hi:[1,0]
    v_pk_fma_f32 v[44:45], v[80:81], v[6:7], v[44:45] op_sel_hi:[1,0,1] neg_lo:[1,0,0] neg_hi:[1,0,0]
    v_pk_fma_f32 v[46:47], v[84:85], v[6:7], v[46:47] op_sel_hi:[1,0,1] neg_lo:[1,0,0] neg_hi:[1,0,0]
    v_pk_fma_f32 v[80:81], v[44:45], v[8:9], v[80:81] op_sel_hi:[1,0,1]
    v_pk_fma_f32 v[84:85], v[46:47], v[8:9], v[84:85] op_sel_hi:[1,0,1]
    v_cvt_pk_bf16_f32 v12, v80, v81
    v_cvt_pk_bf16_f32 v13, v84, v85
    v_pk_add_f32 v[48:49], v[48:49], v[4:5] op_sel_hi:[1,0] neg_lo:[0,1] neg_hi:[0,1]
    v_pk_add_f32 v[50:51], v[50:51], v[4:5] op_sel_hi:[1,0] neg_lo:[0,1] neg_hi:[0,1]
    v_cvt_pk_bf16_f32 v80, v48, v49
    v_cvt_pk_bf16_f32 v84, v50, v51
    v_lshlrev_b32 v48, 16, v80
    v_and_b32 v49, 0xffff0000, v80
    v_lshlrev_b32 v50, 16, v84
    v_and_b32 v51, 0xffff0000, v84
    v_pk_mul_f32 v[80:81], v[48:49], v[8:9] op_sel_hi:[1,0]
    v_pk_mul_f32 v[84:85], v[50:51], v[8:9] op_sel_hi:[1,0]
    v_pk_fma_f32 v[48:49], v[80:81], v[6:7], v[48:49] op_sel_hi:[1,0,1] neg_lo:[1,0,0] neg_hi:[1,0,0]
    v_pk_fma_f32 v[50:51], v[84:85], v[6:7], v[50:51] op_sel_hi:[1,0,1] neg_lo:[1,0,0] neg_hi:[1,0,0]
    v_pk_fma_f32 v[80:81], v[48:49], v[8:9], v[80:81] op_sel_hi:[1,0,1]
    v_pk_fma_f32 v[84:85], v[50:51], v[8:9], v[84:85] op_sel_hi:[1,0,1]
    v_cvt_pk_bf16_f32 v14, v80, v81
    v_cvt_pk_bf16_f32 v15, v84, v85
    v_pk_add_f32 v[52:53], v[52:53], v[4:5] op_sel_hi:[1,0] neg_lo:[0,1] neg_hi:[0,1]
    v_pk_add_f32 v[54:55], v[54:55], v[4:5] op_sel_hi:[1,0] neg_lo:[0,1] neg_hi:[0,1]
    v_cvt_pk_bf16_f32 v80, v52, v53
    v_cvt_pk_bf16_f32 v84, v54, v55
    v_lshlrev_b32 v52, 16, v80
    v_and_b32 v53, 0xffff0000, v80
    v_lshlrev_b32 v54, 16, v84
    v_and_b32 v55, 0xffff0000, v84
    v_pk_mul_f32 v[80:81], v[52:53], v[8:9] op_sel_hi:[1,0]
    v_pk_mul_f32 v[84:85], v[54:55], v[8:9] op_sel_hi:[1,0]
    v_pk_fma_f32 v[52:53], v[80:81], v[6:7], v[52:53] op_sel_hi:[1,0,1] neg_lo:[1,0,0] neg_hi:[1,0,0]
    v_pk_fma_f32 v[54:55], v[84:85], v[6:7], v[54:55] op_sel_hi:[1,0,1] neg_lo:[1,0,0] neg_hi:[1,0,0]
    v_pk_fma_f32 v[80:81], v[52:53], v[8:9], v[80:81] op_sel_hi:[1,0,1]
    v_pk_fma_f32 v[84:85], v[54:55], v[8:9], v[84:85] op_sel_hi:[1,0,1]
    v_cvt_pk_bf16_f32 v16, v80, v81
    v_cvt_pk_bf16_f32 v17, v84, v85
    v_pk_add_f32 v[56:57], v[56:57], v[4:5] op_sel_hi:[1,0] neg_lo:[0,1] neg_hi:[0,1]
    v_pk_add_f32 v[58:59], v[58:59], v[4:5] op_sel_hi:[1,0] neg_lo:[0,1] neg_hi:[0,1]
    v_cvt_pk_bf16_f32 v80, v56, v57
    v_cvt_pk_bf16_f32 v84, v58, v59
    v_lshlrev_b32 v56, 16, v80
    v_and_b32 v57, 0xffff0000, v80
    v_lshlrev_b32 v58, 16, v84
    v_and_b32 v59, 0xffff0000, v84
    v_pk_mul_f32 v[80:81], v[56:57], v[8:9] op_sel_hi:[1,0]
    v_pk_mul_f32 v[84:85], v[58:59], v[8:9] op_sel_hi:[1,0]
    v_pk_fma_f32 v[56:57], v[80:81], v[6:7], v[56:57] op_sel_hi:[1,0,1] neg_lo:[1,0,0] neg_hi:[1,0,0]
    v_pk_fma_f32 v[58:59], v[84:85], v[6:7], v[58:59] op_sel_hi:[1,0,1] neg_lo:[1,0,0] neg_hi:[1,0,0]
    v_pk_fma_f32 v[80:81], v[56:57], v[8:9], v[80:81] op_sel_hi:[1,0,1]
    v_pk_fma_f32 v[84:85], v[58:59], v[8:9], v[84:85] op_sel_hi:[1,0,1]
    v_cvt_pk_bf16_f32 v18, v80, v81
    v_cvt_pk_bf16_f32 v19, v84, v85
    v_pk_add_f32 v[60:61], v[60:61], v[4:5] op_sel_hi:[1,0] neg_lo:[0,1] neg_hi:[0,1]
    v_pk_add_f32 v[62:63], v[62:63], v[4:5] op_sel_hi:[1,0] neg_lo:[0,1] neg_hi:[0,1]
    v_cvt_pk_bf16_f32 v80, v60, v61
    v_cvt_pk_bf16_f32 v84, v62, v63
    v_lshlrev_b32 v60, 16, v80
    v_and_b32 v61, 0xffff0000, v80
    v_lshlrev_b32 v62, 16, v84
    v_and_b32 v63, 0xffff0000, v84
    v_pk_mul_f32 v[80:81], v[60:61], v[8:9] op_sel_hi:[1,0]
    v_pk_mul_f32 v[84:85], v[62:63], v[8:9] op_sel_hi:[1,0]
    v_pk_fma_f32 v[60:61], v[80:81], v[6:7], v[60:61] op_sel_hi:[1,0,1] neg_lo:[1,0,0] neg_hi:[1,0,0]
    v_pk_fma_f32 v[62:63], v[84:85], v[6:7], v[62:63] op_sel_hi:[1,0,1] neg_lo:[1,0,0] neg_hi:[1,0,0]
    v_pk_fma_f32 v[80:81], v[60:61], v[8:9], v[80:81] op_sel_hi:[1,0,1]
    v_pk_fma_f32 v[84:85], v[62:63], v[8:9], v[84:85] op_sel_hi:[1,0,1]
    v_cvt_pk_bf16_f32 v20, v80, v81
    v_cvt_pk_bf16_f32 v21, v84, v85
    v_pk_add_f32 v[64:65], v[64:65], v[4:5] op_sel_hi:[1,0] neg_lo:[0,1] neg_hi:[0,1]
    v_pk_add_f32 v[66:67], v[66:67], v[4:5] op_sel_hi:[1,0] neg_lo:[0,1] neg_hi:[0,1]
    v_cvt_pk_bf16_f32 v80, v64, v65
    v_cvt_pk_bf16_f32 v84, v66, v67
    v_lshlrev_b32 v64, 16, v80
    v_and_b32 v65, 0xffff0000, v80
    v_lshlrev_b32 v66, 16, v84
    v_and_b32 v67, 0xffff0000, v84
    v_pk_mul_f32 v[80:81], v[64:65], v[8:9] op_sel_hi:[1,0]
    v_pk_mul_f32 v[84:85], v[66:67], v[8:9] op_sel_hi:[1,0]
    v_pk_fma_f32 v[64:65], v[80:81], v[6:7], v[64:65] op_sel_hi:[1,0,1] neg_lo:[1,0,0] neg_hi:[1,0,0]
    v_pk_fma_f32 v[66:67], v[84:85], v[6:7], v[66:67] op_sel_hi:[1,0,1] neg_lo:[1,0,0] neg_hi:[1,0,0]
    v_pk_fma_f32 v[80:81], v[64:65], v[8:9], v[80:81] op_sel_hi:[1,0,1]
    v_pk_fma_f32 v[84:85], v[66:67], v[8:9], v[84:85] op_sel_hi:[1,0,1]
    v_cvt_pk_bf16_f32 v22, v80, v81
    v_cvt_pk_bf16_f32 v23, v84, v85
    v_pk_add_f32 v[68:69], v[68:69], v[4:5] op_sel_hi:[1,0] neg_lo:[0,1] neg_hi:[0,1]
    v_pk_add_f32 v[70:71], v[70:71], v[4:5] op_sel_hi:[1,0] neg_lo:[0,1] neg_hi:[0,1]
    v_cvt_pk_bf16_f32 v80, v68, v69
    v_cvt_pk_bf16_f32 v84, v70, v71
    v_lshlrev_b32 v68, 16, v80
    v_and_b32 v69, 0xffff0000, v80
    v_lshlrev_b32 v70, 16, v84
    v_and_b32 v71, 0xffff0000, v84
    v_pk_mul_f32 v[80:81], v[68:69], v[8:9] op_sel_hi:[1,0]
    v_pk_mul_f32 v[84:85], v[70:71], v[8:9] op_sel_hi:[1,0]
    v_pk_fma_f32 v[68:69], v[80:81], v[6:7], v[68:69] op_sel_hi:[1,0,1] neg_lo:[1,0,0] neg_hi:[1,0,0]
    v_pk_fma_f32 v[70:71], v[84:85], v[6:7], v[70:71] op_sel_hi:[1,0,1] neg_lo:[1,0,0] neg_hi:[1,0,0]
    v_pk_fma_f32 v[80:81], v[68:69], v[8:9], v[80:81] op_sel_hi:[1,0,1]
    v_pk_fma_f32 v[84:85], v[70:71], v[8:9], v[84:85] op_sel_hi:[1,0,1]
    v_cvt_pk_bf16_f32 v24, v80, v81
    v_cvt_pk_bf16_f32 v25, v84, v85
    v_pk_add_f32 v[72:73], v[72:73], v[4:5] op_sel_hi:[1,0] neg_lo:[0,1] neg_hi:[0,1]
    v_pk_add_f32 v[74:75], v[74:75], v[4:5] op_sel_hi:[1,0] neg_lo:[0,1] neg_hi:[0,1]
    v_cvt_pk_bf16_f32 v80, v72, v73
    v_cvt_pk_bf16_f32 v84, v74, v75
    v_lshlrev_b32 v72, 16, v80
    v_and_b32 v73, 0xffff0000, v80
    v_lshlrev_b32 v74, 16, v84
    v_and_b32 v75, 0xffff0000, v84
    v_pk_mul_f32 v[80:81], v[72:73], v[8:9] op_sel_hi:[1,0]
    v_pk_mul_f32 v[84:85], v[74:75], v[8:9] op_sel_hi:[1,0]
    v_pk_fma_f32 v[72:73], v[80:81], v[6:7], v[72:73] op_sel_hi:[1,0,1] neg_lo:[1,0,0] neg_hi:[1,0,0]
    v_pk_fma_f32 v[74:75], v[84:85], v[6:7], v[74:75] op_sel_hi:[1,0,1] neg_lo:[1,0,0] neg_hi:[1,0,0]
    v_pk_fma_f32 v[80:81], v[72:73], v[8:9], v[80:81] op_sel_hi:[1,0,1]
    v_pk_fma_f32 v[84:85], v[74:75], v[8:9], v[84:85] op_sel_hi:[1,0,1]
    v_cvt_pk_bf16_f32 v26, v80, v81
    v_cvt_pk_bf16_f32 v27, v84, v85
    v_pk_add_f32 v[76:77], v[76:77], v[4:5] op_sel_hi:[1,0] neg_lo:[0,1] neg_hi:[0,1]
    v_pk_add_f32 v[78:79], v[78:79], v[4:5] op_sel_hi:[1,0] neg_lo:[0,1] neg_hi:[0,1]
    v_cvt_pk_bf16_f32 v80, v76, v77
    v_cvt_pk_bf16_f32 v84, v78, v79
    v_lshlrev_b32 v76, 16, v80
    v_and_b32 v77, 0xffff0000, v80
    v_lshlrev_b32 v78, 16, v84
    v_and_b32 v79, 0xffff0000, v84
    v_pk_mul_f32 v[80:81], v[76:77], v[8:9] op_sel_hi:[1,0]
    v_pk_mul_f32 v[84:85], v[78:79], v[8:9] op_sel_hi:[1,0]
    v_pk_fma_f32 v[76:77], v[80:81], v[6:7], v[76:77] op_sel_hi:[1,0,1] neg_lo:[1,0,0] neg_hi:[1,0,0]
    v_pk_fma_f32 v[78:79], v[84:85], v[6:7], v[78:79] op_sel_hi:[1,0,1] neg_lo:[1,0,0] neg_hi:[1,0,0]
    v_pk_fma_f32 v[80:81], v[76:77], v[8:9], v[80:81] op_sel_hi:[1,0,1]
    v_pk_fma_f32 v[84:85], v[78:79], v[8:9], v[84:85] op_sel_hi:[1,0,1]
    v_cvt_pk_bf16_f32 v28, v80, v81
    v_cvt_pk_bf16_f32 v29, v84, v85
    ds_write_b128 v116, v[10:13] offset:0
    ds_write_b128 v116, v[14:17] offset:256
    ds_write_b128 v116, v[18:21] offset:512
    ds_write_b128 v116, v[22:25] offset:768
    ds_write_b128 v116, v[26:29] offset:1024
    s_waitcnt lgkmcnt(0)
    s_barrier
    ds_read_b128 v[40:43], v117 offset:0
    ds_read_b128 v[44:47], v117 offset:64
    ds_read_b128 v[48:51], v117 offset:128
    ds_read_b128 v[52:55], v117 offset:192
    ds_read_b128 v[56:59], v117 offset:256
    ds_read_b32 v60, v119 offset:0
    ds_read_b32 v61, v119 offset:1296
    ds_read_b32 v62, v119 offset:2592
    ds_read_b32 v63, v119 offset:3888
    ds_read_b32 v64, v119 offset:5184
    ds_read_b32 v65, v119 offset:6480
    ds_read_b32 v66, v119 offset:7776
    ds_read_b32 v67, v119 offset:9072
    ds_read_b32 v68, v119 offset:10368
    ds_read_b32 v69, v119 offset:11664
    ds_read_b32 v70, v119 offset:12960
    ds_read_b32 v71, v119 offset:14256
    ds_read_b32 v72, v119 offset:15552
    ds_read_b32 v73, v119 offset:16848
    ds_read_b32 v74, v119 offset:18144
    ds_read_b32 v75, v119 offset:19440
    s_waitcnt lgkmcnt(15)
    buffer_store_dwordx4 v[40:43], v118, s[36:39], s40 offen offset:0 sc0 sc1
    s_waitcnt lgkmcnt(15)
    buffer_store_dwordx4 v[44:47], v118, s[36:39], s40 offen offset:1024 sc0 sc1
    s_waitcnt lgkmcnt(15)
    buffer_store_dwordx4 v[48:51], v118, s[36:39], s40 offen offset:2048 sc0 sc1
    s_waitcnt lgkmcnt(15)
    buffer_store_dwordx4 v[52:55], v118, s[36:39], s40 offen offset:3072 sc0 sc1
    s_waitcnt lgkmcnt(15)
    buffer_store_dwordx4 v[56:59], v118, s[36:39], s41 offen offset:0 sc0 sc1
    s_cmp_lg_u32 s3, 0
    s_cbranch_scc1 L_lnx_2
    ds_read_b32 v76, v119 offset:1024
    ds_read_b32 v77, v119 offset:2320
    ds_read_b32 v78, v119 offset:3616
    ds_read_b32 v79, v119 offset:4912
    ds_read_b32 v80, v119 offset:6208
    ds_read_b32 v81, v119 offset:7504
    ds_read_b32 v82, v119 offset:8800
    ds_read_b32 v83, v119 offset:10096
    ds_read_b32 v84, v119 offset:11392
    ds_read_b32 v85, v119 offset:12688
    ds_read_b32 v86, v119 offset:13984
    ds_read_b32 v87, v119 offset:15280
    ds_read_b32 v88, v119 offset:16576
    ds_read_b32 v89, v119 offset:17872
    ds_read_b32 v90, v119 offset:19168
    ds_read_b32 v91, v119 offset:20464
L_lnx_2:
    s_waitcnt lgkmcnt(0)
    v_perm_b32 v10, v61, v60, s46
    v_perm_b32 v18, v61, v60, s47
    v_perm_b32 v11, v63, v62, s46
    v_perm_b32 v19, v63, v62, s47
    v_perm_b32 v12, v65, v64, s46
    v_perm_b32 v20, v65, v64, s47
    v_perm_b32 v13, v67, v66, s46
    v_perm_b32 v21, v67, v66, s47
    v_perm_b32 v14, v69, v68, s46
    v_perm_b32 v22, v69, v68, s47
    v_perm_b32 v15, v71, v70, s46
    v_perm_b32 v23, v71, v70, s47
    v_perm_b32 v16, v73, v72, s46
    v_perm_b32 v24, v73, v72, s47
    v_perm_b32 v17, v75, v74, s46
    v_perm_b32 v25, v75, v74, s47
    ds_write_b128 v120, v[10:13] offset:0
    ds_write_b128 v120, v[14:17] offset:16
    ds_write_b128 v120, v[18:21] offset:32
    ds_write_b128 v120, v[22:25] offset:48
    s_waitcnt lgkmcnt(0)
    ds_read_b128 v[26:29], v121 offset:0
    ds_read_b128 v[30:33], v121 offset:1024
    ds_read_b128 v[34:37], v121 offset:2048
    ds_read_b128 v[108:111], v121 offset:3072
    s_waitcnt lgkmcnt(3)
    buffer_store_dwordx4 v[26:29], v118, s[36:39], s44 offen offset:0 sc0 sc1
    s_waitcnt lgkmcnt(2)
    buffer_store_dwordx4 v[30:33], v118, s[36:39], s44 offen offset:1024 sc0 sc1
    s_waitcnt lgkmcnt(1)
    buffer_store_dwordx4 v[34:37], v118, s[36:39], s44 offen offset:2048 sc0 sc1
    s_waitcnt lgkmcnt(0)
    buffer_store_dwordx4 v[108:111], v118, s[36:39], s44 offen offset:3072 sc0 sc1
    s_cmp_lg_u32 s3, 0
    s_cbranch_scc1 L_lnx_3
    v_perm_b32 v92, v77, v76, s46
    v_perm_b32 v100, v77, v76, s47
    v_perm_b32 v93, v79, v78, s46
    v_perm_b32 v101, v79, v78, s47
    v_perm_b32 v94, v81, v80, s46
    v_perm_b32 v102, v81, v80, s47
    v_perm_b32 v95, v83, v82, s46
    v_perm_b32 v103, v83, v82, s47
    v_perm_b32 v96, v85, v84, s46
    v_perm_b32 v104, v85, v84, s47
    v_perm_b32 v97, v87, v86, s46
    v_perm_b32 v105, v87, v86, s47
    v_perm_b32 v98, v89, v88, s46
    v_perm_b32 v106, v89, v88, s47
    v_perm_b32 v99, v91, v90, s46
    v_perm_b32 v107, v91, v90, s47
    ds_write_b128 v120, v[92:95] offset:0
    ds_write_b128 v120, v[96:99] offset:16
    ds_write_b128 v120, v[100:103] offset:32
    ds_write_b128 v120, v[104:107] offset:48
    s_waitcnt lgkmcnt(0)
    ds_read_b128 v[10:13], v121 offset:0
    ds_read_b128 v[14:17], v121 offset:1024
    ds_read_b128 v[18:21], v121 offset:2048
    ds_read_b128 v[22:25], v121 offset:3072
    s_waitcnt lgkmcnt(3)
    buffer_store_dwordx4 v[10:13], v118, s[36:39], s45 offen offset:0 sc0 sc1
    s_waitcnt lgkmcnt(2)
    buffer_store_dwordx4 v[14:17], v118, s[36:39], s45 offen offset:1024 sc0 sc1
    s_waitcnt lgkmcnt(1)
    buffer_store_dwordx4 v[18:21], v118, s[36:39], s45 offen offset:2048 sc0 sc1
    s_waitcnt lgkmcnt(0)
    buffer_store_dwordx4 v[22:25], v118, s[36:39], s45 offen offset:3072 sc0 sc1
L_lnx_3:
    s_branch L_end_p1
L_p1_kg:
    s_lshl_b32 s5, s4, 8
    s_lshl_b32 s6, s3, 6
    s_add_u32 s5, s5, s6
    v_and_b32 v1, 31, v0
    v_lshlrev_b32 v2, 1, v1
    v_add_u32 v2, s5, v2
    s_lshl_b32 s5, s4, 1
    v_mov_b32 v3, s5
    global_load_ushort v10, v2, s[10:11]
    global_load_ushort v11, v2, s[12:13]
    global_load_ushort v12, v2, s[14:15]
    global_load_ushort v13, v2, s[16:17]
    global_load_ushort v14, v3, s[18:19]
    s_branch L_kgz_4
    s_cmp_lg_u32 s3, 0
    s_cbranch_scc1 L_kgz_4
    s_mul_i32 s6, s4, 4352
    s_add_u32 s6, s6, 2621440
    v_mov_b32 v3, 0
    v_lshlrev_b32 v4, 2, v0
    v_cmp_gt_u32 vcc, 60, v0
    s_and_saveexec_b64 s[40:41], vcc
    buffer_store_dword v3, v4, s[36:39], s6 offen sc0 sc1
    s_mov_b64 exec, s[40:41]
L_kgz_4:
    s_mul_i32 s42, s3, 8704
    v_lshrrev_b32 v4, 5, v0
    v_cvt_f32_u32 v9, v4
    v_mul_u32_u24 v4, 2304, v4
    v_lshl_add_u32 v4, v1, 2, v4
    v_add_u32 v4, s42, v4
    v_and_b32 v5, 15, v0
    v_mul_u32_u24 v5, 144, v5
    v_lshrrev_b32 v6, 4, v0
    v_lshl_add_u32 v5, v6, 4, v5
    v_add_u32 v5, s42, v5
    v_lshlrev_b32 v6, 4, v0
    v_add_u32 v6, s42, v6
    s_lshl_b32 s5, s3, 6
    v_add_u32 v1, s5, v0
    v_lshrrev_b32 v60, 7, v1
    v_lshlrev_b32 v60, 3, v60
    v_and_b32 v61, 7, v1
    v_add3_u32 v60, v60, v61, 0
    v_bfe_u32 v96, v1, 3, 4
    v_lshlrev_b32 v96, 4, v96
    v_lshrrev_b32 v61, 2, v60
    v_lshl_add_u32 v96, v61, 8, v96
    v_and_b32 v61, 3, v60
    v_lshl_add_u32 v96, v61, 2, v96
    v_and_b32 v62, 127, v1
    v_lshrrev_b32 v60, 6, v62
    v_lshlrev_b32 v60, 2, v60
    v_and_b32 v61, 3, v62
    v_add3_u32 v60, v60, v61, 16
    v_bfe_u32 v97, v62, 2, 4
    v_lshlrev_b32 v97, 4, v97
    v_lshrrev_b32 v61, 2, v60
    v_lshl_add_u32 v97, v61, 8, v97
    v_and_b32 v61, 3, v60
    v_lshl_add_u32 v97, v61, 2, v97
    v_lshrrev_b32 v60, 5, v62
    v_lshlrev_b32 v60, 1, v60
    v_and_b32 v61, 1, v62
    v_add3_u32 v60, v60, v61, 24
    v_bfe_u32 v98, v62, 1, 4
    v_lshlrev_b32 v98, 4, v98
    v_lshrrev_b32 v61, 2, v60
    v_lshl_add_u32 v98, v61, 8, v98
    v_and_b32 v61, 3, v60
    v_lshl_add_u32 v98, v61, 2, v98
    v_cmp_gt_u32 vcc, 128, v1
    v_cndmask_b32 v97, v98, v97, vcc
    v_min_u32 v62, 128, v1
    v_lshrrev_b32 v60, 4, v62
    v_lshlrev_b32 v60, 0, v60
    v_add_u32 v60, 32, v60
    v_bfe_u32 v98, v62, 0, 4
    v_lshlrev_b32 v98, 4, v98
    v_lshrrev_b32 v61, 2, v60
    v_lshl_add_u32 v98, v61, 8, v98
    v_and_b32 v61, 3, v60
    v_lshl_add_u32 v98, v61, 2, v98
    v_lshlrev_b32 v99, 2, v1
    v_add_u32 v99, 34816, v99
    v_lshlrev_b32 v60, 3, v1
    v_sub_u32 v60, 2049, v60
    v_cvt_f32_u32 v61, v60
    v_lshlrev_b32 v60, 2, v60
    v_add_u32 v60, 34816, v60
    s_mov_b32 s45, 0xffff7e00
    v_subrev_f32 v64, 0.0, v61
    v_max_f32 v64, 0x43000000, v64
    v_subrev_f32 v65, 1.0, v61
    v_max_f32 v65, 0x43000000, v65
    v_subrev_f32 v66, 2.0, v61
    v_max_f32 v66, 0x43000000, v66
    v_subrev_f32 v67, 0x40400000, v61
    v_max_f32 v67, 0x43000000, v67
    v_subrev_f32 v68, 4.0, v61
    v_max_f32 v68, 0x43000000, v68
    v_subrev_f32 v69, 0x40a00000, v61
    v_max_f32 v69, 0x43000000, v69
    v_subrev_f32 v70, 0x40c00000, v61
    v_max_f32 v70, 0x43000000, v70
    v_subrev_f32 v71, 0x40e00000, v61
    v_max_f32 v71, 0x43000000, v71
    v_subrev_f32 v72, 0x41000000, v61
    v_max_f32 v72, 0x43000000, v72
    v_cvt_pk_bf16_f32 v64, v64, v65
    v_cvt_pk_bf16_f32 v66, v66, v67
    v_cvt_pk_bf16_f32 v68, v68, v69
    v_cvt_pk_bf16_f32 v70, v70, v71
    v_cvt_pk_bf16_f32 v72, v72, v72
    v_and_b32 v116, 0xffff, v64
    v_lshl_add_u32 v116, v116, 2, s45
    v_subrev_u32 v73, 0, v60
    v_min_u32 v116, v116, v73
    v_lshrrev_b32 v117, 16, v64
    v_lshl_add_u32 v117, v117, 2, s45
    v_subrev_u32 v73, 4, v60
    v_min_u32 v117, v117, v73
    v_and_b32 v118, 0xffff, v66
    v_lshl_add_u32 v118, v118, 2, s45
    v_subrev_u32 v73, 8, v60
    v_min_u32 v118, v118, v73
    v_lshrrev_b32 v119, 16, v66
    v_lshl_add_u32 v119, v119, 2, s45
    v_subrev_u32 v73, 12, v60
    v_min_u32 v119, v119, v73
    v_and_b32 v120, 0xffff, v68
    v_lshl_add_u32 v120, v120, 2, s45
    v_subrev_u32 v73, 16, v60
    v_min_u32 v120, v120, v73
    v_lshrrev_b32 v121, 16, v68
    v_lshl_add_u32 v121, v121, 2, s45
    v_subrev_u32 v73, 20, v60
    v_min_u32 v121, v121, v73
    v_and_b32 v122, 0xffff, v70
    v_lshl_add_u32 v122, v122, 2, s45
    v_subrev_u32 v73, 24, v60
    v_min_u32 v122, v122, v73
    v_lshrrev_b32 v123, 16, v70
    v_lshl_add_u32 v123, v123, 2, s45
    v_subrev_u32 v73, 28, v60
    v_min_u32 v123, v123, v73
    v_and_b32 v124, 0xffff, v72
    v_lshl_add_u32 v124, v124, 2, s45
    v_subrev_u32 v73, 32, v60
    v_min_u32 v124, v124, v73
    v_lshlrev_b32 v125, 4, v1
    s_mov_b32 s43, 0x3fb8aa3b
    s_mov_b32 s44, 0x3e22f983
    s_mov_b32 vcc_lo, 0
    s_mov_b32 vcc_hi, -1
    v_mov_b32 v100, 0
    v_mov_b32 v101, 0
    v_mov_b32 v102, 0
    v_mov_b32 v103, 0
    v_mov_b32 v104, 0
    v_mov_b32 v105, 0
    v_mov_b32 v106, 0
    v_mov_b32 v107, 0
    v_mov_b32 v108, 0
    v_mov_b32 v109, 0
    v_mov_b32 v110, 0
    v_mov_b32 v111, 0
    v_mov_b32 v112, 0
    v_mov_b32 v113, 0
    v_mov_b32 v114, 0
    v_mov_b32 v115, 0
    s_waitcnt vmcnt(0)
    v_lshlrev_b32 v14, 16, v14
    v_lshlrev_b32 v10, 16, v10
    v_mul_f32 v14, s43, v14
    v_mul_f32 v10, s43, v10
    v_exp_f32 v14, v14
    v_exp_f32 v10, v10
    v_lshlrev_b32 v11, 16, v11
    v_lshlrev_b32 v12, 16, v12
    v_lshlrev_b32 v13, 16, v13
    v_cvt_pk_bf16_f32 v14, v14, v14
    v_lshlrev_b32 v14, 16, v14
    v_cvt_pk_bf16_f32 v10, v10, v10
    v_lshlrev_b32 v10, 16, v10
    v_mul_f32 v10, v10, v14
    v_mul_f32 v11, v11, v14
    v_mul_f32 v12, v12, v14
    v_mul_f32 v13, v13, v14
    v_mul_f32 v10, s43, v10
    v_mul_f32 v11, s44, v11
    v_mul_f32 v12, 0x45000000, v12
    v_mul_f32 v13, 0x45000000, v13
    v_sub_f32 v15, 0, v11
    v_cndmask_b32 v15, v15, v11, vcc
    v_cndmask_b32 v16, 1.0, v12, vcc
    v_cndmask_b32 v17, 0, v13, vcc
    v_mul_f32 v60, 0xc0e00000, v9
    v_add_f32 v60, 0x41000000, v60
    v_mul_f32 v63, 0x42800000, v9
    v_add_f32 v63, 0x42800000, v63
    v_mul_f32 v66, 0x42fc0000, v9
    v_add_f32 v66, 0x40000000, v66
    v_mov_b32 v69, 0x43000000
    v_mul_f32 v72, 0x44400000, v9
    v_add_f32 v72, 0x43800000, v72
    v_mul_f32 v75, 0x44900000, v9
    v_add_f32 v75, 0x43c00000, v75
    v_mul_f32 v78, 0x44c00000, v9
    v_add_f32 v78, 0x44000000, v78
    v_mul_f32 v61, -v10, v60
    v_mul_f32 v62, v15, v60
    v_mul_f32 v64, -v10, v63
    v_mul_f32 v65, v15, v63
    v_mul_f32 v67, -v10, v66
    v_mul_f32 v68, v11, v66
    v_mul_f32 v70, -v10, v69
    v_mul_f32 v71, v11, v69
    v_mul_f32 v73, -v10, v72
    v_mul_f32 v74, v11, v72
    v_mul_f32 v76, -v10, v75
    v_mul_f32 v77, v11, v75
    v_mul_f32 v79, -v10, v78
    v_mul_f32 v80, v11, v78
    v_exp_f32 v61, v61
    v_fract_f32 v62, v62
    v_exp_f32 v64, v64
    v_fract_f32 v65, v65
    v_exp_f32 v67, v67
    v_fract_f32 v68, v68
    v_exp_f32 v70, v70
    v_fract_f32 v71, v71
    v_exp_f32 v73, v73
    v_fract_f32 v74, v74
    v_exp_f32 v76, v76
    v_fract_f32 v77, v77
    v_exp_f32 v79, v79
    v_fract_f32 v80, v80
    v_cos_f32 v18, v62
    v_sin_f32 v19, v62
    v_cos_f32 v20, v65
    v_sin_f32 v21, v65
    v_cos_f32 v22, v68
    v_sin_f32 v23, v68
    v_cos_f32 v24, v71
    v_sin_f32 v25, v71
    v_cos_f32 v26, v74
    v_sin_f32 v27, v74
    v_cos_f32 v28, v77
    v_sin_f32 v29, v77
    v_cos_f32 v30, v80
    v_sin_f32 v31, v80
    s_nop 0
    v_mul_f32 v18, v18, v61
    v_mul_f32 v19, v19, v61
    v_mul_f32 v20, v20, v64
    v_mul_f32 v21, v21, v64
    v_mul_f32 v22, v22, v67
    v_mul_f32 v23, v23, v67
    v_mul_f32 v24, v24, v70
    v_mul_f32 v25, v25, v70
    v_mul_f32 v26, v26, v73
    v_mul_f32 v27, v27, v73
    v_mul_f32 v28, v28, v76
    v_mul_f32 v29, v29, v76
    v_mul_f32 v30, v30, v79
    v_mul_f32 v31, v31, v79
    v_pk_mul_f32 v[32:33], v[18:19], v[18:19] op_sel:[0,0] op_sel_hi:[0,1]
    v_pk_fma_f32 v[32:33], v[18:19], v[18:19], v[32:33] op_sel:[1,1,0] op_sel_hi:[1,0,1] neg_lo:[1,0,0]
    v_pk_mul_f32 v[48:49], v[20:21], v[16:17] op_sel:[0,0] op_sel_hi:[0,1]
    v_pk_fma_f32 v[48:49], v[20:21], v[16:17], v[48:49] op_sel:[1,1,0] op_sel_hi:[1,0,1] neg_lo:[1,0,0]
    v_pk_mul_f32 v[34:35], v[32:33], v[32:33] op_sel:[0,0] op_sel_hi:[0,1]
    v_pk_fma_f32 v[34:35], v[32:33], v[32:33], v[34:35] op_sel:[1,1,0] op_sel_hi:[1,0,1] neg_lo:[1,0,0]
    v_mov_b32 v40, v16
    v_mov_b32 v41, v17
    v_pk_mul_f32 v[44:45], v[34:35], v[16:17] op_sel:[0,0] op_sel_hi:[0,1]
    v_pk_fma_f32 v[44:45], v[34:35], v[16:17], v[44:45] op_sel:[1,1,0] op_sel_hi:[1,0,1] neg_lo:[1,0,0]
    v_pk_mul_f32 v[52:53], v[34:35], v[48:49] op_sel:[0,0] op_sel_hi:[0,1]
    v_pk_fma_f32 v[52:53], v[34:35], v[48:49], v[52:53] op_sel:[1,1,0] op_sel_hi:[1,0,1] neg_lo:[1,0,0]
    v_cvt_pk_f16_f32 v84, v40, v41
    v_cvt_pk_f16_f32 v85, v44, v45
    v_cvt_pk_f16_f32 v86, v48, v49
    v_cvt_pk_f16_f32 v87, v52, v53
    ds_write_b32 v4, v84 offset:0
    ds_write_b32 v4, v85 offset:576
    ds_write_b32 v4, v86 offset:1152
    ds_write_b32 v4, v87 offset:1728
    v_pk_mul_f32 v[42:43], v[40:41], v[18:19] op_sel:[0,0] op_sel_hi:[0,1]
    v_pk_mul_f32 v[46:47], v[44:45], v[18:19] op_sel:[0,0] op_sel_hi:[0,1]
    v_pk_mul_f32 v[50:51], v[48:49], v[18:19] op_sel:[0,0] op_sel_hi:[0,1]
    v_pk_mul_f32 v[54:55], v[52:53], v[18:19] op_sel:[0,0] op_sel_hi:[0,1]
    v_pk_fma_f32 v[42:43], v[40:41], v[18:19], v[42:43] op_sel:[1,1,0] op_sel_hi:[1,0,1] neg_lo:[1,0,0]
    v_pk_fma_f32 v[46:47], v[44:45], v[18:19], v[46:47] op_sel:[1,1,0] op_sel_hi:[1,0,1] neg_lo:[1,0,0]
    v_pk_fma_f32 v[50:51], v[48:49], v[18:19], v[50:51] op_sel:[1,1,0] op_sel_hi:[1,0,1] neg_lo:[1,0,0]
    v_pk_fma_f32 v[54:55], v[52:53], v[18:19], v[54:55] op_sel:[1,1,0] op_sel_hi:[1,0,1] neg_lo:[1,0,0]
    v_cvt_pk_f16_f32 v84, v42, v43
    v_cvt_pk_f16_f32 v85, v46, v47
    v_cvt_pk_f16_f32 v86, v50, v51
    v_cvt_pk_f16_f32 v87, v54, v55
    ds_write_b32 v4, v84 offset:144
    ds_write_b32 v4, v85 offset:720
    ds_write_b32 v4, v86 offset:1296
    ds_write_b32 v4, v87 offset:1872
    v_pk_mul_f32 v[40:41], v[42:43], v[18:19] op_sel:[0,0] op_sel_hi:[0,1]
    v_pk_mul_f32 v[44:45], v[46:47], v[18:19] op_sel:[0,0] op_sel_hi:[0,1]
    v_pk_mul_f32 v[48:49], v[50:51], v[18:19] op_sel:[0,0] op_sel_hi:[0,1]
    v_pk_mul_f32 v[52:53], v[54:55], v[18:19] op_sel:[0,0] op_sel_hi:[0,1]
    v_pk_fma_f32 v[40:41], v[42:43], v[18:19], v[40:41] op_sel:[1,1,0] op_sel_hi:[1,0,1] neg_lo:[1,0,0]
    v_pk_fma_f32 v[44:45], v[46:47], v[18:19], v[44:45] op_sel:[1,1,0] op_sel_hi:[1,0,1] neg_lo:[1,0,0]
    v_pk_fma_f32 v[48:49], v[50:51], v[18:19], v[48:49] op_sel:[1,1,0] op_sel_hi:[1,0,1] neg_lo:[1,0,0]
    v_pk_fma_f32 v[52:53], v[54:55], v[18:19], v[52:53] op_sel:[1,1,0] op_sel_hi:[1,0,1] neg_lo:[1,0,0]
    v_cvt_pk_f16_f32 v84, v40, v41
    v_cvt_pk_f16_f32 v85, v44, v45
    v_cvt_pk_f16_f32 v86, v48, v49
    v_cvt_pk_f16_f32 v87, v52, v53
    ds_write_b32 v4, v84 offset:288
    ds_write_b32 v4, v85 offset:864
    ds_write_b32 v4, v86 offset:1440
    ds_write_b32 v4, v87 offset:2016
    v_pk_mul_f32 v[42:43], v[40:41], v[18:19] op_sel:[0,0] op_sel_hi:[0,1]
    v_pk_mul_f32 v[46:47], v[44:45], v[18:19] op_sel:[0,0] op_sel_hi:[0,1]
    v_pk_mul_f32 v[50:51], v[48:49], v[18:19] op_sel:[0,0] op_sel_hi:[0,1]
    v_pk_mul_f32 v[54:55], v[52:53], v[18:19] op_sel:[0,0] op_sel_hi:[0,1]
    v_pk_fma_f32 v[42:43], v[40:41], v[18:19], v[42:43] op_sel:[1,1,0] op_sel_hi:[1,0,1] neg_lo:[1,0,0]
    v_pk_fma_f32 v[46:47], v[44:45], v[18:19], v[46:47] op_sel:[1,1,0] op_sel_hi:[1,0,1] neg_lo:[1,0,0]
    v_pk_fma_f32 v[50:51], v[48:49], v[18:19], v[50:51] op_sel:[1,1,0] op_sel_hi:[1,0,1] neg_lo:[1,0,0]
    v_pk_fma_f32 v[54:55], v[52:53], v[18:19], v[54:55] op_sel:[1,1,0] op_sel_hi:[1,0,1] neg_lo:[1,0,0]
    v_cvt_pk_f16_f32 v84, v42, v43
    v_cvt_pk_f16_f32 v85, v46, v47
    v_cvt_pk_f16_f32 v86, v50, v51
    v_cvt_pk_f16_f32 v87, v54, v55
    ds_write_b32 v4, v84 offset:432
    ds_write_b32 v4, v85 offset:1008
    ds_write_b32 v4, v86 offset:1584
    ds_write_b32 v4, v87 offset:2160
    ds_read_b128 v[64:67], v5 offset:0
    ds_read_b128 v[72:75], v5 offset:2304
    ds_read_b128 v[68:71], v5 offset:64
    ds_read_b128 v[76:79], v5 offset:2368
    v_pk_mul_f32 v[32:33], v[22:23], v[22:23] op_sel:[0,0] op_sel_hi:[0,1]
    v_pk_fma_f32 v[32:33], v[22:23], v[22:23], v[32:33] op_sel:[1,1,0] op_sel_hi:[1,0,1] neg_lo:[1,0,0]
    v_pk_mul_f32 v[40:41], v[26:27], v[12:13] op_sel:[0,0] op_sel_hi:[0,1]
    v_pk_fma_f32 v[40:41], v[26:27], v[12:13], v[40:41] op_sel:[1,1,0] op_sel_hi:[1,0,1] neg_lo:[1,0,0]
    v_pk_mul_f32 v[44:45], v[28:29], v[12:13] op_sel:[0,0] op_sel_hi:[0,1]
    v_pk_fma_f32 v[44:45], v[28:29], v[12:13], v[44:45] op_sel:[1,1,0] op_sel_hi:[1,0,1] neg_lo:[1,0,0]
    v_pk_mul_f32 v[48:49], v[30:31], v[12:13] op_sel:[0,0] op_sel_hi:[0,1]
    v_pk_fma_f32 v[48:49], v[30:31], v[12:13], v[48:49] op_sel:[1,1,0] op_sel_hi:[1,0,1] neg_lo:[1,0,0]
    v_pk_mul_f32 v[52:53], v[32:33], v[48:49] op_sel:[0,0] op_sel_hi:[0,1]
    v_pk_fma_f32 v[52:53], v[32:33], v[48:49], v[52:53] op_sel:[1,1,0] op_sel_hi:[1,0,1] neg_lo:[1,0,0]
    s_waitcnt lgkmcnt(0)
    v_mfma_f32_16x16x32_f16 v[104:107], v[72:75], v[64:67], v[104:107]
    v_cvt_pk_f16_f32 v84, v40, v41
    v_cvt_pk_f16_f32 v85, v44, v45
    v_cvt_pk_f16_f32 v86, v48, v49
    v_cvt_pk_f16_f32 v87, v52, v53
    ds_write_b32 v4, v84 offset:0
    ds_write_b32 v4, v85 offset:576
    ds_write_b32 v4, v86 offset:1152
    ds_write_b32 v4, v87 offset:1296
    v_pk_mul_f32 v[42:43], v[40:41], v[22:23] op_sel:[0,0] op_sel_hi:[0,1]
    v_pk_mul_f32 v[46:47], v[44:45], v[22:23] op_sel:[0,0] op_sel_hi:[0,1]
    v_pk_mul_f32 v[50:51], v[48:49], v[24:25] op_sel:[0,0] op_sel_hi:[0,1]
    v_pk_mul_f32 v[54:55], v[52:53], v[24:25] op_sel:[0,0] op_sel_hi:[0,1]
    v_pk_fma_f32 v[42:43], v[40:41], v[22:23], v[42:43] op_sel:[1,1,0] op_sel_hi:[1,0,1] neg_lo:[1,0,0]
    v_pk_fma_f32 v[46:47], v[44:45], v[22:23], v[46:47] op_sel:[1,1,0] op_sel_hi:[1,0,1] neg_lo:[1,0,0]
    v_pk_fma_f32 v[50:51], v[48:49], v[24:25], v[50:51] op_sel:[1,1,0] op_sel_hi:[1,0,1] neg_lo:[1,0,0]
    v_pk_fma_f32 v[54:55], v[52:53], v[24:25], v[54:55] op_sel:[1,1,0] op_sel_hi:[1,0,1] neg_lo:[1,0,0]
    v_cvt_pk_f16_f32 v84, v42, v43
    v_cvt_pk_f16_f32 v85, v46, v47
    v_cvt_pk_f16_f32 v86, v50, v51
    v_cvt_pk_f16_f32 v87, v54, v55
    ds_write_b32 v4, v84 offset:144
    ds_write_b32 v4, v85 offset:720
    ds_write_b32 v4, v86 offset:1440
    ds_write_b32 v4, v87 offset:1584
    v_pk_mul_f32 v[40:41], v[42:43], v[22:23] op_sel:[0,0] op_sel_hi:[0,1]
    v_pk_mul_f32 v[44:45], v[46:47], v[22:23] op_sel:[0,0] op_sel_hi:[0,1]
    v_pk_mul_f32 v[48:49], v[50:51], v[24:25] op_sel:[0,0] op_sel_hi:[0,1]
    v_pk_mul_f32 v[52:53], v[54:55], v[24:25] op_sel:[0,0] op_sel_hi:[0,1]
    v_mfma_f32_16x16x32_f16 v[104:107], v[76:79], v[68:71], v[104:107]
    v_pk_fma_f32 v[40:41], v[42:43], v[22:23], v[40:41] op_sel:[1,1,0] op_sel_hi:[1,0,1] neg_lo:[1,0,0]
    v_pk_fma_f32 v[44:45], v[46:47], v[22:23], v[44:45] op_sel:[1,1,0] op_sel_hi:[1,0,1] neg_lo:[1,0,0]
    v_pk_fma_f32 v[48:49], v[50:51], v[24:25], v[48:49] op_sel:[1,1,0] op_sel_hi:[1,0,1] neg_lo:[1,0,0]
    v_pk_fma_f32 v[52:53], v[54:55], v[24:25], v[52:53] op_sel:[1,1,0] op_sel_hi:[1,0,1] neg_lo:[1,0,0]
    v_cvt_pk_f16_f32 v84, v40, v41
    v_cvt_pk_f16_f32 v85, v44, v45
    v_cvt_pk_f16_f32 v86, v48, v49
    v_cvt_pk_f16_f32 v87, v52, v53
    ds_write_b32 v4, v84 offset:288
    ds_write_b32 v4, v85 offset:864
    ds_write_b32 v4, v86 offset:1728
    ds_write_b32 v4, v87 offset:1872
    v_pk_mul_f32 v[42:43], v[40:41], v[22:23] op_sel:[0,0] op_sel_hi:[0,1]
    v_pk_mul_f32 v[46:47], v[44:45], v[22:23] op_sel:[0,0] op_sel_hi:[0,1]
    v_pk_mul_f32 v[50:51], v[48:49], v[24:25] op_sel:[0,0] op_sel_hi:[0,1]
    v_pk_mul_f32 v[54:55], v[52:53], v[24:25] op_sel:[0,0] op_sel_hi:[0,1]
    v_pk_fma_f32 v[42:43], v[40:41], v[22:23], v[42:43] op_sel:[1,1,0] op_sel_hi:[1,0,1] neg_lo:[1,0,0]
    v_pk_fma_f32 v[46:47], v[44:45], v[22:23], v[46:47] op_sel:[1,1,0] op_sel_hi:[1,0,1] neg_lo:[1,0,0]
    v_pk_fma_f32 v[50:51], v[48:49], v[24:25], v[50:51] op_sel:[1,1,0] op_sel_hi:[1,0,1] neg_lo:[1,0,0]
    v_pk_fma_f32 v[54:55], v[52:53], v[24:25], v[54:55] op_sel:[1,1,0] op_sel_hi:[1,0,1] neg_lo:[1,0,0]
    v_cvt_pk_f16_f32 v84, v42, v43
    v_cvt_pk_f16_f32 v85, v46, v47
    v_cvt_pk_f16_f32 v86, v50, v51
    v_cvt_pk_f16_f32 v87, v54, v55
    ds_write_b32 v4, v84 offset:432
    ds_write_b32 v4, v85 offset:1008
    ds_write_b32 v4, v86 offset:2016
    ds_write_b32 v4, v87 offset:2160
    ds_read_b128 v[16:19], v5 offset:0
    ds_read_b128 v[32:35], v5 offset:2304
    ds_read_b128 v[20:23], v5 offset:64
    ds_read_b128 v[36:39], v5 offset:2368
    s_waitcnt lgkmcnt(0)
    v_mfma_f32_16x16x32_f16 v[108:111], v[16:19], v[64:67], v[108:111]
    v_mfma_f32_16x16x32_f16 v[112:115], v[32:35], v[64:67], v[112:115]
    v_mfma_f32_16x16x32_f16 v[108:111], v[20:23], v[68:71], v[108:111]
    v_mfma_f32_16x16x32_f16 v[112:115], v[36:39], v[68:71], v[112:115]
    s_nop 7
    s_nop 7
    ds_write_b128 v6, v[104:107] offset:0
    ds_write_b128 v6, v[108:111] offset:1024
    ds_write_b128 v6, v[112:115] offset:2048
    s_waitcnt lgkmcnt(0)
    s_barrier
    ds_read_b32 v16, v96 offset:0
    ds_read_b32 v17, v96 offset:8704
    ds_read_b32 v18, v96 offset:17408
    ds_read_b32 v19, v96 offset:26112
    ds_read_b32 v20, v97 offset:0
    ds_read_b32 v21, v97 offset:8704
    ds_read_b32 v22, v97 offset:17408
    ds_read_b32 v23, v97 offset:26112
    ds_read_b32 v24, v98 offset:0
    ds_read_b32 v25, v98 offset:8704
    ds_read_b32 v26, v98 offset:17408
    ds_read_b32 v27, v98 offset:26112
    s_waitcnt lgkmcnt(8)
    v_add_f32 v16, v16, v17
    v_add_f32 v18, v18, v19
    v_add_f32 v16, v16, v18
    v_mul_f32 v16, 0x3a800000, v16
    s_waitcnt lgkmcnt(4)
    v_add_f32 v20, v20, v21
    v_add_f32 v22, v22, v23
    v_add_f32 v20, v20, v22
    v_mul_f32 v20, 0x3a800000, v20
    s_waitcnt lgkmcnt(0)
    v_add_f32 v24, v24, v25
    v_add_f32 v26, v26, v27
    v_add_f32 v24, v24, v26
    v_mul_f32 v24, 0x3a800000, v24
    ds_write_b32 v99, v16
    ds_write_b32 v99, v20 offset:1024
    v_cmp_gt_u32 vcc, 129, v1
    s_and_saveexec_b64 s[40:41], vcc
    ds_write_b32 v99, v24 offset:2048
    s_mov_b64 exec, s[40:41]
    s_mul_i32 s6, s4, 4384
    s_add_u32 s6, s6, 9830400
    s_add_u32 s7, s6, 2805760
    s_waitcnt lgkmcnt(0)
    s_barrier
    ds_read_b32 v50, v116
    ds_read_b32 v51, v117
    ds_read_b32 v52, v118
    ds_read_b32 v53, v119
    ds_read_b32 v54, v120
    ds_read_b32 v55, v121
    ds_read_b32 v56, v122
    ds_read_b32 v57, v123
    ds_read_b32 v58, v124
    s_cmp_lg_u32 s3, 3
    s_cbranch_scc1 L_kgx_5
    v_mov_b32 v30, 34816
    ds_read_b64 v[32:33], v30
    v_mov_b32 v36, 0
    v_mov_b32 v37, 0
    v_mov_b32 v38, 0
    v_mov_b32 v39, 0
    v_mov_b32 v40, 0
    v_mov_b32 v41, 0
    v_mov_b32 v42, 0
    v_mov_b32 v43, 0
    v_lshlrev_b32 v31, 4, v0
    v_add_u32 v31, 4096, v31
    v_cmp_eq_u32 vcc, 0, v0
    s_waitcnt lgkmcnt(0)
    v_cvt_pk_bf16_f32 v34, v32, v36
    v_cvt_pk_bf16_f32 v35, v33, v32
    v_cndmask_b32 v36, v36, v34, vcc
    v_cndmask_b32 v40, v40, v35, vcc
    v_cmp_gt_u32 vcc, 18, v0
    s_and_saveexec_b64 s[40:41], vcc
    buffer_store_dwordx4 v[36:39], v31, s[36:39], s6 offen sc0 sc1
    buffer_store_dwordx4 v[40:43], v31, s[36:39], s7 offen sc0 sc1
    s_mov_b64 exec, s[40:41]
L_kgx_5:
    v_cmp_ne_u32 vcc, 0, v1
    s_waitcnt lgkmcnt(0)
    v_cndmask_b32 v50, 0, v50, vcc
    v_cndmask_b32 v51, 0, v51, vcc
    v_cvt_pk_bf16_f32 v60, v51, v52
    v_cvt_pk_bf16_f32 v64, v50, v51
    v_cvt_pk_bf16_f32 v61, v53, v54
    v_cvt_pk_bf16_f32 v65, v52, v53
    v_cvt_pk_bf16_f32 v62, v55, v56
    v_cvt_pk_bf16_f32 v66, v54, v55
    v_cvt_pk_bf16_f32 v63, v57, v58
    v_cvt_pk_bf16_f32 v67, v56, v57
    buffer_store_dwordx4 v[60:63], v125, s[36:39], s6 offen sc0 sc1
    buffer_store_dwordx4 v[64:67], v125, s[36:39], s7 offen sc0 sc1
    s_branch L_end_p1
L_end_p1:
    s_endpgm
.globl mid_kernel
.p2align 8
.type mid_kernel,@function
mid_kernel:
    s_cmp_ge_u32 s2, 896
    s_cbranch_scc1 L_end_p2
    s_load_dwordx16 s[8:23], s[0:1], 0
    s_load_dwordx8 s[24:31], s[0:1], 64
    s_load_dwordx4 s[32:35], s[0:1], 96
    v_lshrrev_b32 v1, 6, v0
    v_and_b32 v0, 63, v0
    s_nop 0
    v_readfirstlane_b32 s3, v1
    s_waitcnt lgkmcnt(0)
    s_mov_b32 s36, s34
    s_and_b32 s37, s35, 0xffff
    s_mov_b32 s38, 25141248
    s_mov_b32 s39, 0x00020000
    s_cmp_lt_u32 s2, 256
    s_cbranch_scc1 L_p2_g1
    s_sub_u32 s4, s2, 256
    s_and_b32 s5, s4, 7
    s_mul_i32 s5, s5, 80
    s_lshr_b32 s4, s4, 3
    s_add_u32 s4, s4, s5
    v_lshlrev_b32 v1, 4, v0
    s_mul_i32 s5, s4, 4384
    s_lshl_b32 s7, s4, 5
    s_mul_i32 s6, s3, 655360
    s_add_u32 s7, s7, s6
    v_lshrrev_b32 v6, 1, v0
    v_mul_u32_u24 v6, 20480, v6
    v_and_b32 v7, 1, v0
    v_lshl_add_u32 v6, v7, 4, v6
    s_add_u32 s7, s7, 2621440
    s_lshr_b32 s40, s3, 1
    s_lshl_b32 s40, s40, 2
    s_sub_u32 s40, 8, s40
    s_add_u32 s40, s40, s5
    s_and_b32 s41, s3, 1
    s_mul_i32 s41, s41, 2805760
    s_add_u32 s40, s40, s41
    s_add_u32 s40, s40, 9830400
    s_mul_i32 s42, s3, 4384
    s_add_u32 m0, s42, 0
    s_add_u32 s6, s40, 0
    buffer_load_dwordx4 v1, s[36:39], s6 offen lds
    s_add_u32 m0, s42, 1024
    s_add_u32 s6, s40, 1024
    buffer_load_dwordx4 v1, s[36:39], s6 offen lds
    s_add_u32 m0, s42, 2048
    s_add_u32 s6, s40, 2048
    buffer_load_dwordx4 v1, s[36:39], s6 offen lds
    s_add_u32 m0, s42, 3072
    s_add_u32 s6, s40, 3072
    buffer_load_dwordx4 v1, s[36:39], s6 offen lds
    s_lshl_b32 s44, s3, 10
    s_add_u32 m0, s44, 17776
    buffer_load_dwordx4 v6, s[36:39], s7 offen lds
    s_mov_b64 exec, 0x1ffff
    s_add_u32 m0, s42, 4096
    s_add_u32 s6, s40, 4096
    buffer_load_dwordx4 v1, s[36:39], s6 offen lds
    s_mov_b64 exec, -1
    v_and_b32 v2, 3, v0
    v_mul_u32_u24 v2, 4384, v2
    v_bfe_u32 v3, v0, 3, 1
    v_lshlrev_b32 v3, 8, v3
    v_sub_u32 v2, v2, v3
    v_bfe_u32 v3, v0, 2, 1
    v_lshlrev_b32 v3, 3, v3
    v_sub_u32 v2, v2, v3
    v_lshrrev_b32 v3, 4, v0
    v_lshl_add_u32 v2, v3, 4, v2
    v_add_u32 v2, 648, v2
    s_lshl_b32 s6, s3, 7
    v_subrev_u32 v2, s6, v2
    v_add_u32 v5, 2048, v2
    v_and_b32 v4, 15, v0
    v_add_u32 v4, v4, v3
    v_lshlrev_b32 v4, 4, v4
    v_add_u32 v4, 17536, v4
    v_subrev_u32 v4, s6, v4
    v_mov_b32 v8, 0
    v_mov_b32 v9, 0
    v_mov_b32 v10, 0
    v_mov_b32 v11, 0
    v_mov_b32 v12, 0
    v_mov_b32 v13, 0
    v_mov_b32 v14, 0
    v_mov_b32 v15, 0
    v_mov_b32 v16, 0
    v_mov_b32 v17, 0
    v_mov_b32 v18, 0
    v_mov_b32 v19, 0
    v_mov_b32 v20, 0
    v_mov_b32 v21, 0
    v_mov_b32 v22, 0
    v_mov_b32 v23, 0
    v_mov_b32 v24, 0
    v_mov_b32 v25, 0
    v_mov_b32 v26, 0
    v_mov_b32 v27, 0
    v_mov_b32 v28, 0
    v_mov_b32 v29, 0
    v_mov_b32 v30, 0
    v_mov_b32 v31, 0
    v_mov_b32 v32, 0
    v_mov_b32 v33, 0
    v_mov_b32 v34, 0
    v_mov_b32 v35, 0
    v_mov_b32 v36, 0
    v_mov_b32 v37, 0
    v_mov_b32 v38, 0
    v_mov_b32 v39, 0
    s_mov_b64 exec, 0x7fff
    ds_write_b128 v1, v[8:11] offset:17536
    s_mov_b64 exec, -1
    s_waitcnt vmcnt(0) lgkmcnt(0)
    s_barrier
    ds_read2_b64 v[40:43], v5 offset0:200 offset1:201
    ds_read_b128 v[72:75], v4 offset:448
    ds_read2_b64 v[44:47], v5 offset0:136 offset1:137
    ds_read_b128 v[76:79], v4 offset:960
    ds_read2_b64 v[48:51], v5 offset0:72 offset1:73
    ds_read_b128 v[80:83], v4 offset:1472
    ds_read2_b64 v[52:55], v5 offset0:8 offset1:9
    ds_read_b128 v[84:87], v4 offset:1984
    ds_read2_b64 v[56:59], v2 offset0:200 offset1:201
    ds_read_b128 v[88:91], v4 offset:2496
    ds_read2_b64 v[60:63], v2 offset0:136 offset1:137
    ds_read_b128 v[92:95], v4 offset:3008
    ds_read2_b64 v[64:67], v2 offset0:72 offset1:73
    ds_read_b128 v[96:99], v4 offset:3520
    ds_read2_b64 v[68:71], v2 offset0:8 offset1:9
    ds_read_b128 v[100:103], v4 offset:4032
    s_waitcnt lgkmcnt(0)
    v_mfma_f32_16x16x32_bf16 v[8:11], v[40:43], v[72:75], v[8:11]
    v_mfma_f32_16x16x32_bf16 v[12:15], v[40:43], v[76:79], v[12:15]
    v_mfma_f32_16x16x32_bf16 v[16:19], v[40:43], v[80:83], v[16:19]
    v_mfma_f32_16x16x32_bf16 v[20:23], v[40:43], v[84:87], v[20:23]
    v_mfma_f32_16x16x32_bf16 v[24:27], v[40:43], v[88:91], v[24:27]
    v_mfma_f32_16x16x32_bf16 v[28:31], v[40:43], v[92:95], v[28:31]
    v_mfma_f32_16x16x32_bf16 v[32:35], v[40:43], v[96:99], v[32:35]
    v_mfma_f32_16x16x32_bf16 v[36:39], v[40:43], v[100:103], v[36:39]
    v_mfma_f32_16x16x32_bf16 v[12:15], v[44:47], v[72:75], v[12:15]
    v_mfma_f32_16x16x32_bf16 v[16:19], v[44:47], v[76:79], v[16:19]
    v_mfma_f32_16x16x32_bf16 v[20:23], v[44:47], v[80:83], v[20:23]
    v_mfma_f32_16x16x32_bf16 v[24:27], v[44:47], v[84:87], v[24:27]
    v_mfma_f32_16x16x32_bf16 v[28:31], v[44:47], v[88:91], v[28:31]
    v_mfma_f32_16x16x32_bf16 v[32:35], v[44:47], v[92:95], v[32:35]
    v_mfma_f32_16x16x32_bf16 v[36:39], v[44:47], v[96:99], v[36:39]
    v_mfma_f32_16x16x32_bf16 v[16:19], v[48:51], v[72:75], v[16:19]
    v_mfma_f32_16x16x32_bf16 v[20:23], v[48:51], v[76:79], v[20:23]
    v_mfma_f32_16x16x32_bf16 v[24:27], v[48:51], v[80:83], v[24:27]
    v_mfma_f32_16x16x32_bf16 v[28:31], v[48:51], v[84:87], v[28:31]
    v_mfma_f32_16x16x32_bf16 v[32:35], v[48:51], v[88:91], v[32:35]
    v_mfma_f32_16x16x32_bf16 v[36:39], v[48:51], v[92:95], v[36:39]
    v_mfma_f32_16x16x32_bf16 v[20:23], v[52:55], v[72:75], v[20:23]
    v_mfma_f32_16x16x32_bf16 v[24:27], v[52:55], v[76:79], v[24:27]
    v_mfma_f32_16x16x32_bf16 v[28:31], v[52:55], v[80:83], v[28:31]
    v_mfma_f32_16x16x32_bf16 v[32:35], v[52:55], v[84:87], v[32:35]
    v_mfma_f32_16x16x32_bf16 v[36:39], v[52:55], v[88:91], v[36:39]
    v_mfma_f32_16x16x32_bf16 v[24:27], v[56:59], v[72:75], v[24:27]
    v_mfma_f32_16x16x32_bf16 v[28:31], v[56:59], v[76:79], v[28:31]
    v_mfma_f32_16x16x32_bf16 v[32:35], v[56:59], v[80:83], v[32:35]
    v_mfma_f32_16x16x32_bf16 v[36:39], v[56:59], v[84:87], v[36:39]
    v_mfma_f32_16x16x32_bf16 v[28:31], v[60:63], v[72:75], v[28:31]
    v_mfma_f32_16x16x32_bf16 v[32:35], v[60:63], v[76:79], v[32:35]
    v_mfma_f32_16x16x32_bf16 v[36:39], v[60:63], v[80:83], v[36:39]
    v_mfma_f32_16x16x32_bf16 v[32:35], v[64:67], v[72:75], v[32:35]
    v_mfma_f32_16x16x32_bf16 v[36:39], v[64:67], v[76:79], v[36:39]
    v_mfma_f32_16x16x32_bf16 v[36:39], v[68:71], v[72:75], v[36:39]
    ds_read2_b64 v[40:43], v5 offset0:192 offset1:193
    ds_read_b128 v[72:75], v4 offset:384
    ds_read2_b64 v[44:47], v5 offset0:128 offset1:129
    ds_read_b128 v[76:79], v4 offset:896
    ds_read2_b64 v[48:51], v5 offset0:64 offset1:65
    ds_read_b128 v[80:83], v4 offset:1408
    ds_read2_b64 v[52:55], v5 offset0:0 offset1:1
    ds_read_b128 v[84:87], v4 offset:1920
    ds_read2_b64 v[56:59], v2 offset0:192 offset1:193
    ds_read_b128 v[88:91], v4 offset:2432
    ds_read2_b64 v[60:63], v2 offset0:128 offset1:129
    ds_read_b128 v[92:95], v4 offset:2944
    ds_read2_b64 v[64:67], v2 offset0:64 offset1:65
    ds_read_b128 v[96:99], v4 offset:3456
    ds_read2_b64 v[68:71], v2 offset0:0 offset1:1
    ds_read_b128 v[100:103], v4 offset:3968
    s_waitcnt lgkmcnt(0)
    v_mfma_f32_16x16x32_bf16 v[8:11], v[40:43], v[72:75], v[8:11]
    v_mfma_f32_16x16x32_bf16 v[12:15], v[40:43], v[76:79], v[12:15]
    v_mfma_f32_16x16x32_bf16 v[16:19], v[40:43], v[80:83], v[16:19]
    v_mfma_f32_16x16x32_bf16 v[20:23], v[40:43], v[84:87], v[20:23]
    v_mfma_f32_16x16x32_bf16 v[24:27], v[40:43], v[88:91], v[24:27]
    v_mfma_f32_16x16x32_bf16 v[28:31], v[40:43], v[92:95], v[28:31]
    v_mfma_f32_16x16x32_bf16 v[32:35], v[40:43], v[96:99], v[32:35]
    v_mfma_f32_16x16x32_bf16 v[36:39], v[40:43], v[100:103], v[36:39]
    v_mfma_f32_16x16x32_bf16 v[12:15], v[44:47], v[72:75], v[12:15]
    v_mfma_f32_16x16x32_bf16 v[16:19], v[44:47], v[76:79], v[16:19]
    v_mfma_f32_16x16x32_bf16 v[20:23], v[44:47], v[80:83], v[20:23]
    v_mfma_f32_16x16x32_bf16 v[24:27], v[44:47], v[84:87], v[24:27]
    v_mfma_f32_16x16x32_bf16 v[28:31], v[44:47], v[88:91], v[28:31]
    v_mfma_f32_16x16x32_bf16 v[32:35], v[44:47], v[92:95], v[32:35]
    v_mfma_f32_16x16x32_bf16 v[36:39], v[44:47], v[96:99], v[36:39]
    v_mfma_f32_16x16x32_bf16 v[16:19], v[48:51], v[72:75], v[16:19]
    v_mfma_f32_16x16x32_bf16 v[20:23], v[48:51], v[76:79], v[20:23]
    v_mfma_f32_16x16x32_bf16 v[24:27], v[48:51], v[80:83], v[24:27]
    v_mfma_f32_16x16x32_bf16 v[28:31], v[48:51], v[84:87], v[28:31]
    v_mfma_f32_16x16x32_bf16 v[32:35], v[48:51], v[88:91], v[32:35]
    v_mfma_f32_16x16x32_bf16 v[36:39], v[48:51], v[92:95], v[36:39]
    v_mfma_f32_16x16x32_bf16 v[20:23], v[52:55], v[72:75], v[20:23]
    v_mfma_f32_16x16x32_bf16 v[24:27], v[52:55], v[76:79], v[24:27]
    v_mfma_f32_16x16x32_bf16 v[28:31], v[52:55], v[80:83], v[28:31]
    v_mfma_f32_16x16x32_bf16 v[32:35], v[52:55], v[84:87], v[32:35]
    v_mfma_f32_16x16x32_bf16 v[36:39], v[52:55], v[88:91], v[36:39]
    v_mfma_f32_16x16x32_bf16 v[24:27], v[56:59], v[72:75], v[24:27]
    v_mfma_f32_16x16x32_bf16 v[28:31], v[56:59], v[76:79], v[28:31]
    v_mfma_f32_16x16x32_bf16 v[32:35], v[56:59], v[80:83], v[32:35]
    v_mfma_f32_16x16x32_bf16 v[36:39], v[56:59], v[84:87], v[36:39]
    v_mfma_f32_16x16x32_bf16 v[28:31], v[60:63], v[72:75], v[28:31]
    v_mfma_f32_16x16x32_bf16 v[32:35], v[60:63], v[76:79], v[32:35]
    v_mfma_f32_16x16x32_bf16 v[36:39], v[60:63], v[80:83], v[36:39]
    v_mfma_f32_16x16x32_bf16 v[32:35], v[64:67], v[72:75], v[32:35]
    v_mfma_f32_16x16x32_bf16 v[36:39], v[64:67], v[76:79], v[36:39]
    v_mfma_f32_16x16x32_bf16 v[36:39], v[68:71], v[72:75], v[36:39]
    s_nop 7
    s_barrier
    s_lshl_b32 s6, s3, 13
    v_add_u32 v5, s6, v1
    ds_write_b128 v5, v[8:11] offset:0
    ds_write_b128 v5, v[12:15] offset:1024
    ds_write_b128 v5, v[16:19] offset:2048
    ds_write_b128 v5, v[20:23] offset:3072
    ds_write_b128 v5, v[24:27] offset:4096
    ds_write_b128 v5, v[28:31] offset:5120
    ds_write_b128 v5, v[32:35] offset:6144
    ds_write_b128 v5, v[36:39] offset:7168
    s_waitcnt lgkmcnt(0)
    s_barrier
    s_lshl_b32 s6, s3, 11
    v_add_u32 v5, s6, v1
    ds_read_b128 v[40:43], v5 offset:0
    ds_read_b128 v[44:47], v5 offset:8192
    ds_read_b128 v[48:51], v5 offset:16384
    ds_read_b128 v[52:55], v5 offset:24576
    ds_read_b128 v[56:59], v5 offset:1024
    ds_read_b128 v[60:63], v5 offset:9216
    ds_read_b128 v[64:67], v5 offset:17408
    ds_read_b128 v[68:71], v5 offset:25600
    v_lshrrev_b32 v6, 5, v0
    v_lshlrev_b32 v6, 8, v6
    v_and_b32 v7, 15, v0
    v_lshl_add_u32 v6, v7, 4, v6
    v_bfe_u32 v7, v0, 4, 1
    v_lshl_add_u32 v6, v7, 3, v6
    s_lshl_b32 s6, s4, 12
    s_lshl_b32 s7, s3, 10
    s_add_u32 s6, s6, s7
    s_add_u32 s6, s6, 22519808
    s_waitcnt lgkmcnt(0)
    v_add_f32 v40, v40, v44
    v_add_f32 v48, v48, v52
    v_add_f32 v41, v41, v45
    v_add_f32 v49, v49, v53
    v_add_f32 v42, v42, v46
    v_add_f32 v50, v50, v54
    v_add_f32 v43, v43, v47
    v_add_f32 v51, v51, v55
    v_add_f32 v40, v40, v48
    v_add_f32 v41, v41, v49
    v_add_f32 v42, v42, v50
    v_add_f32 v43, v43, v51
    v_cvt_pk_bf16_f32 v44, v40, v41
    v_cvt_pk_bf16_f32 v45, v42, v43
    buffer_store_dwordx2 v[44:45], v6, s[36:39], s6 offen offset:0 sc0 sc1
    v_add_f32 v56, v56, v60
    v_add_f32 v64, v64, v68
    v_add_f32 v57, v57, v61
    v_add_f32 v65, v65, v69
    v_add_f32 v58, v58, v62
    v_add_f32 v66, v66, v70
    v_add_f32 v59, v59, v63
    v_add_f32 v67, v67, v71
    v_add_f32 v56, v56, v64
    v_add_f32 v57, v57, v65
    v_add_f32 v58, v58, v66
    v_add_f32 v59, v59, v67
    v_cvt_pk_bf16_f32 v60, v56, v57
    v_cvt_pk_bf16_f32 v61, v58, v59
    buffer_store_dwordx2 v[60:61], v6, s[36:39], s6 offen offset:512 sc0 sc1
    s_branch L_end_p2
L_p2_g1:
    s_lshr_b32 s4, s2, 4
    s_and_b32 s5, s2, 7
    s_lshl_b32 s5, s5, 1
    s_bfe_u32 s6, s2, 0x10003
    s_add_u32 s5, s5, s6
    s_mul_i32 s6, s4, 7
    s_mul_i32 s7, s4, 6
    s_add_u32 s7, s7, 12
    s_cmp_lt_u32 s4, 12
    s_cselect_b32 s4, s6, s7
    s_cselect_b32 s45, 6, 5
    s_add_u32 s6, s3, 0
    s_lshl_b32 s56, s6, 10
    s_min_u32 s40, s6, s45
    s_add_u32 s40, s40, s4
    s_mul_i32 s40, s40, 20480
    s_add_u32 s48, s40, 5406720
    s_add_u32 s6, s3, 4
    s_lshl_b32 s57, s6, 10
    s_min_u32 s40, s6, s45
    s_add_u32 s40, s40, s4
    s_mul_i32 s40, s40, 20480
    s_add_u32 s49, s40, 5406720
    s_lshl_b32 s40, s5, 3
    s_lshl_b32 s41, s3, 1
    s_add_u32 s40, s40, s41
    s_mul_i32 s40, s40, 20480
    s_add_u32 s54, s40, 0
    v_lshlrev_b32 v1, 4, v0
    s_add_u32 m0, s56, 0
    s_add_u32 s6, s48, 0
    buffer_load_dwordx4 v1, s[36:39], s6 offen lds
    s_add_u32 m0, s57, 0
    s_add_u32 s6, s49, 0
    buffer_load_dwordx4 v1, s[36:39], s6 offen lds
    s_add_u32 s7, s54, 0
    buffer_load_dwordx4 v[120:123], v1, s[36:39], s7 offen
    s_add_u32 s7, s54, 20480
    buffer_load_dwordx4 v[124:127], v1, s[36:39], s7 offen
    s_add_u32 m0, s56, 8192
    s_add_u32 s6, s48, 1024
    buffer_load_dwordx4 v1, s[36:39], s6 offen lds
    s_add_u32 m0, s57, 8192
    s_add_u32 s6, s49, 1024
    buffer_load_dwordx4 v1, s[36:39], s6 offen lds
    s_add_u32 s7, s54, 1024
    buffer_load_dwordx4 v[128:131], v1, s[36:39], s7 offen
    s_add_u32 s7, s54, 21504
    buffer_load_dwordx4 v[132:135], v1, s[36:39], s7 offen
    s_add_u32 m0, s56, 16384
    s_add_u32 s6, s48, 2048
    buffer_load_dwordx4 v1, s[36:39], s6 offen lds
    s_add_u32 m0, s57, 16384
    s_add_u32 s6, s49, 2048
    buffer_load_dwordx4 v1, s[36:39], s6 offen lds
    s_add_u32 s7, s54, 2048
    buffer_load_dwordx4 v[136:139], v1, s[36:39], s7 offen
    s_add_u32 s7, s54, 22528
    buffer_load_dwordx4 v[140:143], v1, s[36:39], s7 offen
    s_add_u32 m0, s56, 24576
    s_add_u32 s6, s48, 3072
    buffer_load_dwordx4 v1, s[36:39], s6 offen lds
    s_add_u32 m0, s57, 24576
    s_add_u32 s6, s49, 3072
    buffer_load_dwordx4 v1, s[36:39], s6 offen lds
    s_add_u32 m0, s56, 32768
    s_add_u32 s6, s48, 4096
    buffer_load_dwordx4 v1, s[36:39], s6 offen lds
    s_add_u32 m0, s57, 32768
    s_add_u32 s6, s49, 4096
    buffer_load_dwordx4 v1, s[36:39], s6 offen lds
    s_lshl_b32 s6, s4, 5
    v_lshrrev_b32 v6, 4, v0
    v_lshlrev_b32 v6, 3, v6
    v_add_u32 v6, s6, v6
    s_lshl_b32 s6, s45, 5
    v_add_u32 v7, s6, v6
    global_load_dwordx2 v[152:153], v6, s[26:27] offset:0
    global_load_dwordx2 v[154:155], v6, s[26:27] offset:32
    global_load_dwordx2 v[156:157], v6, s[26:27] offset:64
    global_load_dwordx2 v[158:159], v6, s[26:27] offset:96
    global_load_dwordx2 v[160:161], v6, s[26:27] offset:128
    global_load_dwordx2 v[162:163], v6, s[26:27] offset:160
    global_load_dwordx2 v[164:165], v7, s[26:27]
    v_mov_b32 v8, 0
    v_mov_b32 v9, 0
    v_mov_b32 v10, 0
    v_mov_b32 v11, 0
    v_mov_b32 v12, 0
    v_mov_b32 v13, 0
    v_mov_b32 v14, 0
    v_mov_b32 v15, 0
    v_mov_b32 v16, 0
    v_mov_b32 v17, 0
    v_mov_b32 v18, 0
    v_mov_b32 v19, 0
    v_mov_b32 v20, 0
    v_mov_b32 v21, 0
    v_mov_b32 v22, 0
    v_mov_b32 v23, 0
    v_mov_b32 v24, 0
    v_mov_b32 v25, 0
    v_mov_b32 v26, 0
    v_mov_b32 v27, 0
    v_mov_b32 v28, 0
    v_mov_b32 v29, 0
    v_mov_b32 v30, 0
    v_mov_b32 v31, 0
    v_mov_b32 v32, 0
    v_mov_b32 v33, 0
    v_mov_b32 v34, 0
    v_mov_b32 v35, 0
    v_mov_b32 v36, 0
    v_mov_b32 v37, 0
    v_mov_b32 v38, 0
    v_mov_b32 v39, 0
    v_mov_b32 v40, 0
    v_mov_b32 v41, 0
    v_mov_b32 v42, 0
    v_mov_b32 v43, 0
    v_mov_b32 v44, 0
    v_mov_b32 v45, 0
    v_mov_b32 v46, 0
    v_mov_b32 v47, 0
    v_mov_b32 v48, 0
    v_mov_b32 v49, 0
    v_mov_b32 v50, 0
    v_mov_b32 v51, 0
    v_mov_b32 v52, 0
    v_mov_b32 v53, 0
    v_mov_b32 v54, 0
    v_mov_b32 v55, 0
    v_mov_b32 v56, 0
    v_mov_b32 v57, 0
    v_mov_b32 v58, 0
    v_mov_b32 v59, 0
    v_mov_b32 v60, 0
    v_mov_b32 v61, 0
    v_mov_b32 v62, 0
    v_mov_b32 v63, 0
    s_waitcnt vmcnt(21)
    s_barrier
    ds_read_b128 v[64:67], v1 offset:0
    ds_read_b128 v[68:71], v1 offset:1024
    ds_read_b128 v[72:75], v1 offset:2048
    ds_read_b128 v[76:79], v1 offset:3072
    ds_read_b128 v[80:83], v1 offset:4096
    ds_read_b128 v[84:87], v1 offset:5120
    ds_read_b128 v[88:91], v1 offset:6144
    s_waitcnt lgkmcnt(0)
    s_waitcnt vmcnt(17)
    s_barrier
    v_mfma_f32_16x16x32_bf16 v[8:11], v[64:67], v[120:123], v[8:11]
    ds_read_b128 v[92:95], v1 offset:8192
    v_mfma_f32_16x16x32_bf16 v[12:15], v[64:67], v[124:127], v[12:15]
    s_add_u32 m0, s56, 0
    s_add_u32 s6, s48, 5120
    buffer_load_dwordx4 v1, s[36:39], s6 offen lds
    v_mfma_f32_16x16x32_bf16 v[16:19], v[68:71], v[120:123], v[16:19]
    ds_read_b128 v[96:99], v1 offset:9216
    v_mfma_f32_16x16x32_bf16 v[20:23], v[68:71], v[124:127], v[20:23]
    s_add_u32 m0, s57, 0
    s_add_u32 s6, s49, 5120
    buffer_load_dwordx4 v1, s[36:39], s6 offen lds
    v_mfma_f32_16x16x32_bf16 v[24:27], v[72:75], v[120:123], v[24:27]
    v_mfma_f32_16x16x32_bf16 v[28:31], v[72:75], v[124:127], v[28:31]
    ds_read_b128 v[100:103], v1 offset:10240
    v_mfma_f32_16x16x32_bf16 v[32:35], v[76:79], v[120:123], v[32:35]
    ds_read_b128 v[104:107], v1 offset:11264
    v_mfma_f32_16x16x32_bf16 v[36:39], v[76:79], v[124:127], v[36:39]
    s_add_u32 s7, s54, 3072
    buffer_load_dwordx4 v[144:147], v1, s[36:39], s7 offen
    v_mfma_f32_16x16x32_bf16 v[40:43], v[80:83], v[120:123], v[40:43]
    ds_read_b128 v[108:111], v1 offset:12288
    v_mfma_f32_16x16x32_bf16 v[44:47], v[80:83], v[124:127], v[44:47]
    v_mfma_f32_16x16x32_bf16 v[48:51], v[84:87], v[120:123], v[48:51]
    ds_read_b128 v[112:115], v1 offset:13312
    v_mfma_f32_16x16x32_bf16 v[52:55], v[84:87], v[124:127], v[52:55]
    s_add_u32 s7, s54, 23552
    buffer_load_dwordx4 v[148:151], v1, s[36:39], s7 offen
    v_mfma_f32_16x16x32_bf16 v[56:59], v[88:91], v[120:123], v[56:59]
    ds_read_b128 v[116:119], v1 offset:14336
    v_mfma_f32_16x16x32_bf16 v[60:63], v[88:91], v[124:127], v[60:63]
    s_waitcnt lgkmcnt(0)
    s_waitcnt vmcnt(17)
    s_barrier
    v_mfma_f32_16x16x32_bf16 v[8:11], v[92:95], v[128:131], v[8:11]
    ds_read_b128 v[64:67], v1 offset:16384
    v_mfma_f32_16x16x32_bf16 v[12:15], v[92:95], v[132:135], v[12:15]
    s_add_u32 m0, s56, 8192
    s_add_u32 s6, s48, 6144
    buffer_load_dwordx4 v1, s[36:39], s6 offen lds
    v_mfma_f32_16x16x32_bf16 v[16:19], v[96:99], v[128:131], v[16:19]
    ds_read_b128 v[68:71], v1 offset:17408
    v_mfma_f32_16x16x32_bf16 v[20:23], v[96:99], v[132:135], v[20:23]
    s_add_u32 m0, s57, 8192
    s_add_u32 s6, s49, 6144
    buffer_load_dwordx4 v1, s[36:39], s6 offen lds
    v_mfma_f32_16x16x32_bf16 v[24:27], v[100:103], v[128:131], v[24:27]
    v_mfma_f32_16x16x32_bf16 v[28:31], v[100:103], v[132:135], v[28:31]
    ds_read_b128 v[72:75], v1 offset:18432
    v_mfma_f32_16x16x32_bf16 v[32:35], v[104:107], v[128:131], v[32:35]
    ds_read_b128 v[76:79], v1 offset:19456
    v_mfma_f32_16x16x32_bf16 v[36:39], v[104:107], v[132:135], v[36:39]
    s_add_u32 s7, s54, 4096
    buffer_load_dwordx4 v[120:123], v1, s[36:39], s7 offen
    v_mfma_f32_16x16x32_bf16 v[40:43], v[108:111], v[128:131], v[40:43]
    ds_read_b128 v[80:83], v1 offset:20480
    v_mfma_f32_16x16x32_bf16 v[44:47], v[108:111], v[132:135], v[44:47]
    v_mfma_f32_16x16x32_bf16 v[48:51], v[112:115], v[128:131], v[48:51]
    ds_read_b128 v[84:87], v1 offset:21504
    v_mfma_f32_16x16x32_bf16 v[52:55], v[112:115], v[132:135], v[52:55]
    s_add_u32 s7, s54, 24576
    buffer_load_dwordx4 v[124:127], v1, s[36:39], s7 offen
    v_mfma_f32_16x16x32_bf16 v[56:59], v[116:119], v[128:131], v[56:59]
    ds_read_b128 v[88:91], v1 offset:22528
    v_mfma_f32_16x16x32_bf16 v[60:63], v[116:119], v[132:135], v[60:63]
    s_waitcnt lgkmcnt(0)
    s_waitcnt vmcnt(17)
    s_barrier
    v_mfma_f32_16x16x32_bf16 v[8:11], v[64:67], v[136:139], v[8:11]
    ds_read_b128 v[92:95], v1 offset:24576
    v_mfma_f32_16x16x32_bf16 v[12:15], v[64:67], v[140:143], v[12:15]
    s_add_u32 m0, s56, 16384
    s_add_u32 s6, s48, 7168
    buffer_load_dwordx4 v1, s[36:39], s6 offen lds
    v_mfma_f32_16x16x32_bf16 v[16:19], v[68:71], v[136:139], v[16:19]
    ds_read_b128 v[96:99], v1 offset:25600
    v_mfma_f32_16x16x32_bf16 v[20:23], v[68:71], v[140:143], v[20:23]
    s_add_u32 m0, s57, 16384
    s_add_u32 s6, s49, 7168
    buffer_load_dwordx4 v1, s[36:39], s6 offen lds
    v_mfma_f32_16x16x32_bf16 v[24:27], v[72:75], v[136:139], v[24:27]
    v_mfma_f32_16x16x32_bf16 v[28:31], v[72:75], v[140:143], v[28:31]
    ds_read_b128 v[100:103], v1 offset:26624
    v_mfma_f32_16x16x32_bf16 v[32:35], v[76:79], v[136:139], v[32:35]
    ds_read_b128 v[104:107], v1 offset:27648
    v_mfma_f32_16x16x32_bf16 v[36:39], v[76:79], v[140:143], v[36:39]
    s_add_u32 s7, s54, 5120
    buffer_load_dwordx4 v[128:131], v1, s[36:39], s7 offen
    v_mfma_f32_16x16x32_bf16 v[40:43], v[80:83], v[136:139], v[40:43]
    ds_read_b128 v[108:111], v1 offset:28672
    v_mfma_f32_16x16x32_bf16 v[44:47], v[80:83], v[140:143], v[44:47]
    v_mfma_f32_16x16x32_bf16 v[48:51], v[84:87], v[136:139], v[48:51]
    ds_read_b128 v[112:115], v1 offset:29696
    v_mfma_f32_16x16x32_bf16 v[52:55], v[84:87], v[140:143], v[52:55]
    s_add_u32 s7, s54, 25600
    buffer_load_dwordx4 v[132:135], v1, s[36:39], s7 offen
    v_mfma_f32_16x16x32_bf16 v[56:59], v[88:91], v[136:139], v[56:59]
    ds_read_b128 v[116:119], v1 offset:30720
    v_mfma_f32_16x16x32_bf16 v[60:63], v[88:91], v[140:143], v[60:63]
    s_waitcnt lgkmcnt(0)
    s_waitcnt vmcnt(8)
    s_barrier
    v_mfma_f32_16x16x32_bf16 v[8:11], v[92:95], v[144:147], v[8:11]
    ds_read_b128 v[64:67], v1 offset:32768
    v_mfma_f32_16x16x32_bf16 v[12:15], v[92:95], v[148:151], v[12:15]
    s_add_u32 m0, s56, 24576
    s_add_u32 s6, s48, 8192
    buffer_load_dwordx4 v1, s[36:39], s6 offen lds
    v_mfma_f32_16x16x32_bf16 v[16:19], v[96:99], v[144:147], v[16:19]
    ds_read_b128 v[68:71], v1 offset:33792
    v_mfma_f32_16x16x32_bf16 v[20:23], v[96:99], v[148:151], v[20:23]
    s_add_u32 m0, s57, 24576
    s_add_u32 s6, s49, 8192
    buffer_load_dwordx4 v1, s[36:39], s6 offen lds
    v_mfma_f32_16x16x32_bf16 v[24:27], v[100:103], v[144:147], v[24:27]
    v_mfma_f32_16x16x32_bf16 v[28:31], v[100:103], v[148:151], v[28:31]
    ds_read_b128 v[72:75], v1 offset:34816
    v_mfma_f32_16x16x32_bf16 v[32:35], v[104:107], v[144:147], v[32:35]
    ds_read_b128 v[76:79], v1 offset:35840
    v_mfma_f32_16x16x32_bf16 v[36:39], v[104:107], v[148:151], v[36:39]
    s_add_u32 s7, s54, 6144
    buffer_load_dwordx4 v[136:139], v1, s[36:39], s7 offen
    v_mfma_f32_16x16x32_bf16 v[40:43], v[108:111], v[144:147], v[40:43]
    ds_read_b128 v[80:83], v1 offset:36864
    v_mfma_f32_16x16x32_bf16 v[44:47], v[108:111], v[148:151], v[44:47]
    v_mfma_f32_16x16x32_bf16 v[48:51], v[112:115], v[144:147], v[48:51]
    ds_read_b128 v[84:87], v1 offset:37888
    v_mfma_f32_16x16x32_bf16 v[52:55], v[112:115], v[148:151], v[52:55]
    s_add_u32 s7, s54, 26624
    buffer_load_dwordx4 v[140:143], v1, s[36:39], s7 offen
    v_mfma_f32_16x16x32_bf16 v[56:59], v[116:119], v[144:147], v[56:59]
    ds_read_b128 v[88:91], v1 offset:38912
    v_mfma_f32_16x16x32_bf16 v[60:63], v[116:119], v[148:151], v[60:63]
    s_waitcnt lgkmcnt(0)
    s_waitcnt vmcnt(8)
    s_barrier
    v_mfma_f32_16x16x32_bf16 v[8:11], v[64:67], v[120:123], v[8:11]
    ds_read_b128 v[92:95], v1 offset:0
    v_mfma_f32_16x16x32_bf16 v[12:15], v[64:67], v[124:127], v[12:15]
    s_add_u32 m0, s56, 32768
    s_add_u32 s6, s48, 9216
    buffer_load_dwordx4 v1, s[36:39], s6 offen lds
    v_mfma_f32_16x16x32_bf16 v[16:19], v[68:71], v[120:123], v[16:19]
    ds_read_b128 v[96:99], v1 offset:1024
    v_mfma_f32_16x16x32_bf16 v[20:23], v[68:71], v[124:127], v[20:23]
    s_add_u32 m0, s57, 32768
    s_add_u32 s6, s49, 9216
    buffer_load_dwordx4 v1, s[36:39], s6 offen lds
    v_mfma_f32_16x16x32_bf16 v[24:27], v[72:75], v[120:123], v[24:27]
    v_mfma_f32_16x16x32_bf16 v[28:31], v[72:75], v[124:127], v[28:31]
    ds_read_b128 v[100:103], v1 offset:2048
    v_mfma_f32_16x16x32_bf16 v[32:35], v[76:79], v[120:123], v[32:35]
    ds_read_b128 v[104:107], v1 offset:3072
    v_mfma_f32_16x16x32_bf16 v[36:39], v[76:79], v[124:127], v[36:39]
    s_add_u32 s7, s54, 7168
    buffer_load_dwordx4 v[144:147], v1, s[36:39], s7 offen
    v_mfma_f32_16x16x32_bf16 v[40:43], v[80:83], v[120:123], v[40:43]
    ds_read_b128 v[108:111], v1 offset:4096
    v_mfma_f32_16x16x32_bf16 v[44:47], v[80:83], v[124:127], v[44:47]
    v_mfma_f32_16x16x32_bf16 v[48:51], v[84:87], v[120:123], v[48:51]
    ds_read_b128 v[112:115], v1 offset:5120
    v_mfma_f32_16x16x32_bf16 v[52:55], v[84:87], v[124:127], v[52:55]
    s_add_u32 s7, s54, 27648
    buffer_load_dwordx4 v[148:151], v1, s[36:39], s7 offen
    v_mfma_f32_16x16x32_bf16 v[56:59], v[88:91], v[120:123], v[56:59]
    ds_read_b128 v[116:119], v1 offset:6144
    v_mfma_f32_16x16x32_bf16 v[60:63], v[88:91], v[124:127], v[60:63]
    s_waitcnt lgkmcnt(0)
    s_waitcnt vmcnt(8)
    s_barrier
    v_mfma_f32_16x16x32_bf16 v[8:11], v[92:95], v[128:131], v[8:11]
    ds_read_b128 v[64:67], v1 offset:8192
    v_mfma_f32_16x16x32_bf16 v[12:15], v[92:95], v[132:135], v[12:15]
    s_add_u32 m0, s56, 0
    s_add_u32 s6, s48, 10240
    buffer_load_dwordx4 v1, s[36:39], s6 offen lds
    v_mfma_f32_16x16x32_bf16 v[16:19], v[96:99], v[128:131], v[16:19]
    ds_read_b128 v[68:71], v1 offset:9216
    v_mfma_f32_16x16x32_bf16 v[20:23], v[96:99], v[132:135], v[20:23]
    s_add_u32 m0, s57, 0
    s_add_u32 s6, s49, 10240
    buffer_load_dwordx4 v1, s[36:39], s6 offen lds
    v_mfma_f32_16x16x32_bf16 v[24:27], v[100:103], v[128:131], v[24:27]
    v_mfma_f32_16x16x32_bf16 v[28:31], v[100:103], v[132:135], v[28:31]
    ds_read_b128 v[72:75], v1 offset:10240
    v_mfma_f32_16x16x32_bf16 v[32:35], v[104:107], v[128:131], v[32:35]
    ds_read_b128 v[76:79], v1 offset:11264
    v_mfma_f32_16x16x32_bf16 v[36:39], v[104:107], v[132:135], v[36:39]
    s_add_u32 s7, s54, 8192
    buffer_load_dwordx4 v[120:123], v1, s[36:39], s7 offen
    v_mfma_f32_16x16x32_bf16 v[40:43], v[108:111], v[128:131], v[40:43]
    ds_read_b128 v[80:83], v1 offset:12288
    v_mfma_f32_16x16x32_bf16 v[44:47], v[108:111], v[132:135], v[44:47]
    v_mfma_f32_16x16x32_bf16 v[48:51], v[112:115], v[128:131], v[48:51]
    ds_read_b128 v[84:87], v1 offset:13312
    v_mfma_f32_16x16x32_bf16 v[52:55], v[112:115], v[132:135], v[52:55]
    s_add_u32 s7, s54, 28672
    buffer_load_dwordx4 v[124:127], v1, s[36:39], s7 offen
    v_mfma_f32_16x16x32_bf16 v[56:59], v[116:119], v[128:131], v[56:59]
    ds_read_b128 v[88:91], v1 offset:14336
    v_mfma_f32_16x16x32_bf16 v[60:63], v[116:119], v[132:135], v[60:63]
    s_waitcnt lgkmcnt(0)
    s_waitcnt vmcnt(8)
    s_barrier
    v_mfma_f32_16x16x32_bf16 v[8:11], v[64:67], v[136:139], v[8:11]
    ds_read_b128 v[92:95], v1 offset:16384
    v_mfma_f32_16x16x32_bf16 v[12:15], v[64:67], v[140:143], v[12:15]
    s_add_u32 m0, s56, 8192
    s_add_u32 s6, s48, 11264
    buffer_load_dwordx4 v1, s[36:39], s6 offen lds
    v_mfma_f32_16x16x32_bf16 v[16:19], v[68:71], v[136:139], v[16:19]
    ds_read_b128 v[96:99], v1 offset:17408
    v_mfma_f32_16x16x32_bf16 v[20:23], v[68:71], v[140:143], v[20:23]
    s_add_u32 m0, s57, 8192
    s_add_u32 s6, s49, 11264
    buffer_load_dwordx4 v1, s[36:39], s6 offen lds
    v_mfma_f32_16x16x32_bf16 v[24:27], v[72:75], v[136:139], v[24:27]
    v_mfma_f32_16x16x32_bf16 v[28:31], v[72:75], v[140:143], v[28:31]
    ds_read_b128 v[100:103], v1 offset:18432
    v_mfma_f32_16x16x32_bf16 v[32:35], v[76:79], v[136:139], v[32:35]
    ds_read_b128 v[104:107], v1 offset:19456
    v_mfma_f32_16x16x32_bf16 v[36:39], v[76:79], v[140:143], v[36:39]
    s_add_u32 s7, s54, 9216
    buffer_load_dwordx4 v[128:131], v1, s[36:39], s7 offen
    v_mfma_f32_16x16x32_bf16 v[40:43], v[80:83], v[136:139], v[40:43]
    ds_read_b128 v[108:111], v1 offset:20480
    v_mfma_f32_16x16x32_bf16 v[44:47], v[80:83], v[140:143], v[44:47]
    v_mfma_f32_16x16x32_bf16 v[48:51], v[84:87], v[136:139], v[48:51]
    ds_read_b128 v[112:115], v1 offset:21504
    v_mfma_f32_16x16x32_bf16 v[52:55], v[84:87], v[140:143], v[52:55]
    s_add_u32 s7, s54, 29696
    buffer_load_dwordx4 v[132:135], v1, s[36:39], s7 offen
    v_mfma_f32_16x16x32_bf16 v[56:59], v[88:91], v[136:139], v[56:59]
    ds_read_b128 v[116:119], v1 offset:22528
    v_mfma_f32_16x16x32_bf16 v[60:63], v[88:91], v[140:143], v[60:63]
    s_waitcnt lgkmcnt(0)
    s_waitcnt vmcnt(8)
    s_barrier
    v_mfma_f32_16x16x32_bf16 v[8:11], v[92:95], v[144:147], v[8:11]
    ds_read_b128 v[64:67], v1 offset:24576
    v_mfma_f32_16x16x32_bf16 v[12:15], v[92:95], v[148:151], v[12:15]
    s_add_u32 m0, s56, 16384
    s_add_u32 s6, s48, 12288
    buffer_load_dwordx4 v1, s[36:39], s6 offen lds
    v_mfma_f32_16x16x32_bf16 v[16:19], v[96:99], v[144:147], v[16:19]
    ds_read_b128 v[68:71], v1 offset:25600
    v_mfma_f32_16x16x32_bf16 v[20:23], v[96:99], v[148:151], v[20:23]
    s_add_u32 m0, s57, 16384
    s_add_u32 s6, s49, 12288
    buffer_load_dwordx4 v1, s[36:39], s6 offen lds
    v_mfma_f32_16x16x32_bf16 v[24:27], v[100:103], v[144:147], v[24:27]
    v_mfma_f32_16x16x32_bf16 v[28:31], v[100:103], v[148:151], v[28:31]
    ds_read_b128 v[72:75], v1 offset:26624
    v_mfma_f32_16x16x32_bf16 v[32:35], v[104:107], v[144:147], v[32:35]
    ds_read_b128 v[76:79], v1 offset:27648
    v_mfma_f32_16x16x32_bf16 v[36:39], v[104:107], v[148:151], v[36:39]
    s_add_u32 s7, s54, 10240
    buffer_load_dwordx4 v[136:139], v1, s[36:39], s7 offen
    v_mfma_f32_16x16x32_bf16 v[40:43], v[108:111], v[144:147], v[40:43]
    ds_read_b128 v[80:83], v1 offset:28672
    v_mfma_f32_16x16x32_bf16 v[44:47], v[108:111], v[148:151], v[44:47]
    v_mfma_f32_16x16x32_bf16 v[48:51], v[112:115], v[144:147], v[48:51]
    ds_read_b128 v[84:87], v1 offset:29696
    v_mfma_f32_16x16x32_bf16 v[52:55], v[112:115], v[148:151], v[52:55]
    s_add_u32 s7, s54, 30720
    buffer_load_dwordx4 v[140:143], v1, s[36:39], s7 offen
    v_mfma_f32_16x16x32_bf16 v[56:59], v[116:119], v[144:147], v[56:59]
    ds_read_b128 v[88:91], v1 offset:30720
    v_mfma_f32_16x16x32_bf16 v[60:63], v[116:119], v[148:151], v[60:63]
    s_waitcnt lgkmcnt(0)
    s_waitcnt vmcnt(8)
    s_barrier
    v_mfma_f32_16x16x32_bf16 v[8:11], v[64:67], v[120:123], v[8:11]
    ds_read_b128 v[92:95], v1 offset:32768
    v_mfma_f32_16x16x32_bf16 v[12:15], v[64:67], v[124:127], v[12:15]
    s_add_u32 m0, s56, 24576
    s_add_u32 s6, s48, 13312
    buffer_load_dwordx4 v1, s[36:39], s6 offen lds
    v_mfma_f32_16x16x32_bf16 v[16:19], v[68:71], v[120:123], v[16:19]
    ds_read_b128 v[96:99], v1 offset:33792
    v_mfma_f32_16x16x32_bf16 v[20:23], v[68:71], v[124:127], v[20:23]
    s_add_u32 m0, s57, 24576
    s_add_u32 s6, s49, 13312
    buffer_load_dwordx4 v1, s[36:39], s6 offen lds
    v_mfma_f32_16x16x32_bf16 v[24:27], v[72:75], v[120:123], v[24:27]
    v_mfma_f32_16x16x32_bf16 v[28:31], v[72:75], v[124:127], v[28:31]
    ds_read_b128 v[100:103], v1 offset:34816
    v_mfma_f32_16x16x32_bf16 v[32:35], v[76:79], v[120:123], v[32:35]
    ds_read_b128 v[104:107], v1 offset:35840
    v_mfma_f32_16x16x32_bf16 v[36:39], v[76:79], v[124:127], v[36:39]
    s_add_u32 s7, s54, 11264
    buffer_load_dwordx4 v[144:147], v1, s[36:39], s7 offen
    v_mfma_f32_16x16x32_bf16 v[40:43], v[80:83], v[120:123], v[40:43]
    ds_read_b128 v[108:111], v1 offset:36864
    v_mfma_f32_16x16x32_bf16 v[44:47], v[80:83], v[124:127], v[44:47]
    v_mfma_f32_16x16x32_bf16 v[48:51], v[84:87], v[120:123], v[48:51]
    ds_read_b128 v[112:115], v1 offset:37888
    v_mfma_f32_16x16x32_bf16 v[52:55], v[84:87], v[124:127], v[52:55]
    s_add_u32 s7, s54, 31744
    buffer_load_dwordx4 v[148:151], v1, s[36:39], s7 offen
    v_mfma_f32_16x16x32_bf16 v[56:59], v[88:91], v[120:123], v[56:59]
    ds_read_b128 v[116:119], v1 offset:38912
    v_mfma_f32_16x16x32_bf16 v[60:63], v[88:91], v[124:127], v[60:63]
    s_waitcnt lgkmcnt(0)
    s_waitcnt vmcnt(8)
    s_barrier
    v_mfma_f32_16x16x32_bf16 v[8:11], v[92:95], v[128:131], v[8:11]
    ds_read_b128 v[64:67], v1 offset:0
    v_mfma_f32_16x16x32_bf16 v[12:15], v[92:95], v[132:135], v[12:15]
    s_add_u32 m0, s56, 32768
    s_add_u32 s6, s48, 14336
    buffer_load_dwordx4 v1, s[36:39], s6 offen lds
    v_mfma_f32_16x16x32_bf16 v[16:19], v[96:99], v[128:131], v[16:19]
    ds_read_b128 v[68:71], v1 offset:1024
    v_mfma_f32_16x16x32_bf16 v[20:23], v[96:99], v[132:135], v[20:23]
    s_add_u32 m0, s57, 32768
    s_add_u32 s6, s49, 14336
    buffer_load_dwordx4 v1, s[36:39], s6 offen lds
    v_mfma_f32_16x16x32_bf16 v[24:27], v[100:103], v[128:131], v[24:27]
    v_mfma_f32_16x16x32_bf16 v[28:31], v[100:103], v[132:135], v[28:31]
    ds_read_b128 v[72:75], v1 offset:2048
    v_mfma_f32_16x16x32_bf16 v[32:35], v[104:107], v[128:131], v[32:35]
    ds_read_b128 v[76:79], v1 offset:3072
    v_mfma_f32_16x16x32_bf16 v[36:39], v[104:107], v[132:135], v[36:39]
    s_add_u32 s7, s54, 12288
    buffer_load_dwordx4 v[120:123], v1, s[36:39], s7 offen
    v_mfma_f32_16x16x32_bf16 v[40:43], v[108:111], v[128:131], v[40:43]
    ds_read_b128 v[80:83], v1 offset:4096
    v_mfma_f32_16x16x32_bf16 v[44:47], v[108:111], v[132:135], v[44:47]
    v_mfma_f32_16x16x32_bf16 v[48:51], v[112:115], v[128:131], v[48:51]
    ds_read_b128 v[84:87], v1 offset:5120
    v_mfma_f32_16x16x32_bf16 v[52:55], v[112:115], v[132:135], v[52:55]
    s_add_u32 s7, s54, 32768
    buffer_load_dwordx4 v[124:127], v1, s[36:39], s7 offen
    v_mfma_f32_16x16x32_bf16 v[56:59], v[116:119], v[128:131], v[56:59]
    ds_read_b128 v[88:91], v1 offset:6144
    v_mfma_f32_16x16x32_bf16 v[60:63], v[116:119], v[132:135], v[60:63]
    s_waitcnt lgkmcnt(0)
    s_waitcnt vmcnt(8)
    s_barrier
    v_mfma_f32_16x16x32_bf16 v[8:11], v[64:67], v[136:139], v[8:11]
    ds_read_b128 v[92:95], v1 offset:8192
    v_mfma_f32_16x16x32_bf16 v[12:15], v[64:67], v[140:143], v[12:15]
    s_add_u32 m0, s56, 0
    s_add_u32 s6, s48, 15360
    buffer_load_dwordx4 v1, s[36:39], s6 offen lds
    v_mfma_f32_16x16x32_bf16 v[16:19], v[68:71], v[136:139], v[16:19]
    ds_read_b128 v[96:99], v1 offset:9216
    v_mfma_f32_16x16x32_bf16 v[20:23], v[68:71], v[140:143], v[20:23]
    s_add_u32 m0, s57, 0
    s_add_u32 s6, s49, 15360
    buffer_load_dwordx4 v1, s[36:39], s6 offen lds
    v_mfma_f32_16x16x32_bf16 v[24:27], v[72:75], v[136:139], v[24:27]
    v_mfma_f32_16x16x32_bf16 v[28:31], v[72:75], v[140:143], v[28:31]
    ds_read_b128 v[100:103], v1 offset:10240
    v_mfma_f32_16x16x32_bf16 v[32:35], v[76:79], v[136:139], v[32:35]
    ds_read_b128 v[104:107], v1 offset:11264
    v_mfma_f32_16x16x32_bf16 v[36:39], v[76:79], v[140:143], v[36:39]
    s_add_u32 s7, s54, 13312
    buffer_load_dwordx4 v[128:131], v1, s[36:39], s7 offen
    v_mfma_f32_16x16x32_bf16 v[40:43], v[80:83], v[136:139], v[40:43]
    ds_read_b128 v[108:111], v1 offset:12288
    v_mfma_f32_16x16x32_bf16 v[44:47], v[80:83], v[140:143], v[44:47]
    v_mfma_f32_16x16x32_bf16 v[48:51], v[84:87], v[136:139], v[48:51]
    ds_read_b128 v[112:115], v1 offset:13312
    v_mfma_f32_16x16x32_bf16 v[52:55], v[84:87], v[140:143], v[52:55]
    s_add_u32 s7, s54, 33792
    buffer_load_dwordx4 v[132:135], v1, s[36:39], s7 offen
    v_mfma_f32_16x16x32_bf16 v[56:59], v[88:91], v[136:139], v[56:59]
    ds_read_b128 v[116:119], v1 offset:14336
    v_mfma_f32_16x16x32_bf16 v[60:63], v[88:91], v[140:143], v[60:63]
    s_waitcnt lgkmcnt(0)
    s_waitcnt vmcnt(8)
    s_barrier
    v_mfma_f32_16x16x32_bf16 v[8:11], v[92:95], v[144:147], v[8:11]
    ds_read_b128 v[64:67], v1 offset:16384
    v_mfma_f32_16x16x32_bf16 v[12:15], v[92:95], v[148:151], v[12:15]
    s_add_u32 m0, s56, 8192
    s_add_u32 s6, s48, 16384
    buffer_load_dwordx4 v1, s[36:39], s6 offen lds
    v_mfma_f32_16x16x32_bf16 v[16:19], v[96:99], v[144:147], v[16:19]
    ds_read_b128 v[68:71], v1 offset:17408
    v_mfma_f32_16x16x32_bf16 v[20:23], v[96:99], v[148:151], v[20:23]
    s_add_u32 m0, s57, 8192
    s_add_u32 s6, s49, 16384
    buffer_load_dwordx4 v1, s[36:39], s6 offen lds
    v_mfma_f32_16x16x32_bf16 v[24:27], v[100:103], v[144:147], v[24:27]
    v_mfma_f32_16x16x32_bf16 v[28:31], v[100:103], v[148:151], v[28:31]
    ds_read_b128 v[72:75], v1 offset:18432
    v_mfma_f32_16x16x32_bf16 v[32:35], v[104:107], v[144:147], v[32:35]
    ds_read_b128 v[76:79], v1 offset:19456
    v_mfma_f32_16x16x32_bf16 v[36:39], v[104:107], v[148:151], v[36:39]
    s_add_u32 s7, s54, 14336
    buffer_load_dwordx4 v[136:139], v1, s[36:39], s7 offen
    v_mfma_f32_16x16x32_bf16 v[40:43], v[108:111], v[144:147], v[40:43]
    ds_read_b128 v[80:83], v1 offset:20480
    v_mfma_f32_16x16x32_bf16 v[44:47], v[108:111], v[148:151], v[44:47]
    v_mfma_f32_16x16x32_bf16 v[48:51], v[112:115], v[144:147], v[48:51]
    ds_read_b128 v[84:87], v1 offset:21504
    v_mfma_f32_16x16x32_bf16 v[52:55], v[112:115], v[148:151], v[52:55]
    s_add_u32 s7, s54, 34816
    buffer_load_dwordx4 v[140:143], v1, s[36:39], s7 offen
    v_mfma_f32_16x16x32_bf16 v[56:59], v[116:119], v[144:147], v[56:59]
    ds_read_b128 v[88:91], v1 offset:22528
    v_mfma_f32_16x16x32_bf16 v[60:63], v[116:119], v[148:151], v[60:63]
    s_waitcnt lgkmcnt(0)
    s_waitcnt vmcnt(8)
    s_barrier
    v_mfma_f32_16x16x32_bf16 v[8:11], v[64:67], v[120:123], v[8:11]
    ds_read_b128 v[92:95], v1 offset:24576
    v_mfma_f32_16x16x32_bf16 v[12:15], v[64:67], v[124:127], v[12:15]
    s_add_u32 m0, s56, 16384
    s_add_u32 s6, s48, 17408
    buffer_load_dwordx4 v1, s[36:39], s6 offen lds
    v_mfma_f32_16x16x32_bf16 v[16:19], v[68:71], v[120:123], v[16:19]
    ds_read_b128 v[96:99], v1 offset:25600
    v_mfma_f32_16x16x32_bf16 v[20:23], v[68:71], v[124:127], v[20:23]
    s_add_u32 m0, s57, 16384
    s_add_u32 s6, s49, 17408
    buffer_load_dwordx4 v1, s[36:39], s6 offen lds
    v_mfma_f32_16x16x32_bf16 v[24:27], v[72:75], v[120:123], v[24:27]
    v_mfma_f32_16x16x32_bf16 v[28:31], v[72:75], v[124:127], v[28:31]
    ds_read_b128 v[100:103], v1 offset:26624
    v_mfma_f32_16x16x32_bf16 v[32:35], v[76:79], v[120:123], v[32:35]
    ds_read_b128 v[104:107], v1 offset:27648
    v_mfma_f32_16x16x32_bf16 v[36:39], v[76:79], v[124:127], v[36:39]
    s_add_u32 s7, s54, 15360
    buffer_load_dwordx4 v[144:147], v1, s[36:39], s7 offen
    v_mfma_f32_16x16x32_bf16 v[40:43], v[80:83], v[120:123], v[40:43]
    ds_read_b128 v[108:111], v1 offset:28672
    v_mfma_f32_16x16x32_bf16 v[44:47], v[80:83], v[124:127], v[44:47]
    v_mfma_f32_16x16x32_bf16 v[48:51], v[84:87], v[120:123], v[48:51]
    ds_read_b128 v[112:115], v1 offset:29696
    v_mfma_f32_16x16x32_bf16 v[52:55], v[84:87], v[124:127], v[52:55]
    s_add_u32 s7, s54, 35840
    buffer_load_dwordx4 v[148:151], v1, s[36:39], s7 offen
    v_mfma_f32_16x16x32_bf16 v[56:59], v[88:91], v[120:123], v[56:59]
    ds_read_b128 v[116:119], v1 offset:30720
    v_mfma_f32_16x16x32_bf16 v[60:63], v[88:91], v[124:127], v[60:63]
    s_waitcnt lgkmcnt(0)
    s_waitcnt vmcnt(8)
    s_barrier
    v_mfma_f32_16x16x32_bf16 v[8:11], v[92:95], v[128:131], v[8:11]
    ds_read_b128 v[64:67], v1 offset:32768
    v_mfma_f32_16x16x32_bf16 v[12:15], v[92:95], v[132:135], v[12:15]
    s_add_u32 m0, s56, 24576
    s_add_u32 s6, s48, 18432
    buffer_load_dwordx4 v1, s[36:39], s6 offen lds
    v_mfma_f32_16x16x32_bf16 v[16:19], v[96:99], v[128:131], v[16:19]
    ds_read_b128 v[68:71], v1 offset:33792
    v_mfma_f32_16x16x32_bf16 v[20:23], v[96:99], v[132:135], v[20:23]
    s_add_u32 m0, s57, 24576
    s_add_u32 s6, s49, 18432
    buffer_load_dwordx4 v1, s[36:39], s6 offen lds
    v_mfma_f32_16x16x32_bf16 v[24:27], v[100:103], v[128:131], v[24:27]
    v_mfma_f32_16x16x32_bf16 v[28:31], v[100:103], v[132:135], v[28:31]
    ds_read_b128 v[72:75], v1 offset:34816
    v_mfma_f32_16x16x32_bf16 v[32:35], v[104:107], v[128:131], v[32:35]
    ds_read_b128 v[76:79], v1 offset:35840
    v_mfma_f32_16x16x32_bf16 v[36:39], v[104:107], v[132:135], v[36:39]
    s_add_u32 s7, s54, 16384
    buffer_load_dwordx4 v[120:123], v1, s[36:39], s7 offen
    v_mfma_f32_16x16x32_bf16 v[40:43], v[108:111], v[128:131], v[40:43]
    ds_read_b128 v[80:83], v1 offset:36864
    v_mfma_f32_16x16x32_bf16 v[44:47], v[108:111], v[132:135], v[44:47]
    v_mfma_f32_16x16x32_bf16 v[48:51], v[112:115], v[128:131], v[48:51]
    ds_read_b128 v[84:87], v1 offset:37888
    v_mfma_f32_16x16x32_bf16 v[52:55], v[112:115], v[132:135], v[52:55]
    s_add_u32 s7, s54, 36864
    buffer_load_dwordx4 v[124:127], v1, s[36:39], s7 offen
    v_mfma_f32_16x16x32_bf16 v[56:59], v[116:119], v[128:131], v[56:59]
    ds_read_b128 v[88:91], v1 offset:38912
    v_mfma_f32_16x16x32_bf16 v[60:63], v[116:119], v[132:135], v[60:63]
    s_waitcnt lgkmcnt(0)
    s_waitcnt vmcnt(8)
    s_barrier
    v_mfma_f32_16x16x32_bf16 v[8:11], v[64:67], v[136:139], v[8:11]
    ds_read_b128 v[92:95], v1 offset:0
    v_mfma_f32_16x16x32_bf16 v[12:15], v[64:67], v[140:143], v[12:15]
    s_add_u32 m0, s56, 32768
    s_add_u32 s6, s48, 19456
    buffer_load_dwordx4 v1, s[36:39], s6 offen lds
    v_mfma_f32_16x16x32_bf16 v[16:19], v[68:71], v[136:139], v[16:19]
    ds_read_b128 v[96:99], v1 offset:1024
    v_mfma_f32_16x16x32_bf16 v[20:23], v[68:71], v[140:143], v[20:23]
    s_add_u32 m0, s57, 32768
    s_add_u32 s6, s49, 19456
    buffer_load_dwordx4 v1, s[36:39], s6 offen lds
    v_mfma_f32_16x16x32_bf16 v[24:27], v[72:75], v[136:139], v[24:27]
    v_mfma_f32_16x16x32_bf16 v[28:31], v[72:75], v[140:143], v[28:31]
    ds_read_b128 v[100:103], v1 offset:2048
    v_mfma_f32_16x16x32_bf16 v[32:35], v[76:79], v[136:139], v[32:35]
    ds_read_b128 v[104:107], v1 offset:3072
    v_mfma_f32_16x16x32_bf16 v[36:39], v[76:79], v[140:143], v[36:39]
    s_add_u32 s7, s54, 17408
    buffer_load_dwordx4 v[128:131], v1, s[36:39], s7 offen
    v_mfma_f32_16x16x32_bf16 v[40:43], v[80:83], v[136:139], v[40:43]
    ds_read_b128 v[108:111], v1 offset:4096
    v_mfma_f32_16x16x32_bf16 v[44:47], v[80:83], v[140:143], v[44:47]
    v_mfma_f32_16x16x32_bf16 v[48:51], v[84:87], v[136:139], v[48:51]
    ds_read_b128 v[112:115], v1 offset:5120
    v_mfma_f32_16x16x32_bf16 v[52:55], v[84:87], v[140:143], v[52:55]
    s_add_u32 s7, s54, 37888
    buffer_load_dwordx4 v[132:135], v1, s[36:39], s7 offen
    v_mfma_f32_16x16x32_bf16 v[56:59], v[88:91], v[136:139], v[56:59]
    ds_read_b128 v[116:119], v1 offset:6144
    v_mfma_f32_16x16x32_bf16 v[60:63], v[88:91], v[140:143], v[60:63]
    s_waitcnt lgkmcnt(0)
    s_waitcnt vmcnt(8)
    s_barrier
    v_mfma_f32_16x16x32_bf16 v[8:11], v[92:95], v[144:147], v[8:11]
    ds_read_b128 v[64:67], v1 offset:8192
    v_mfma_f32_16x16x32_bf16 v[12:15], v[92:95], v[148:151], v[12:15]
    ds_read_b128 v[68:71], v1 offset:9216
    v_mfma_f32_16x16x32_bf16 v[16:19], v[96:99], v[144:147], v[16:19]
    v_mfma_f32_16x16x32_bf16 v[20:23], v[96:99], v[148:151], v[20:23]
    s_add_u32 s7, s54, 18432
    buffer_load_dwordx4 v[136:139], v1, s[36:39], s7 offen
    v_mfma_f32_16x16x32_bf16 v[24:27], v[100:103], v[144:147], v[24:27]
    ds_read_b128 v[72:75], v1 offset:10240
    v_mfma_f32_16x16x32_bf16 v[28:31], v[100:103], v[148:151], v[28:31]
    v_mfma_f32_16x16x32_bf16 v[32:35], v[104:107], v[144:147], v[32:35]
    ds_read_b128 v[76:79], v1 offset:11264
    v_mfma_f32_16x16x32_bf16 v[36:39], v[104:107], v[148:151], v[36:39]
    s_add_u32 s7, s54, 38912
    buffer_load_dwordx4 v[140:143], v1, s[36:39], s7 offen
    v_mfma_f32_16x16x32_bf16 v[40:43], v[108:111], v[144:147], v[40:43]
    v_mfma_f32_16x16x32_bf16 v[44:47], v[108:111], v[148:151], v[44:47]
    ds_read_b128 v[80:83], v1 offset:12288
    v_mfma_f32_16x16x32_bf16 v[48:51], v[112:115], v[144:147], v[48:51]
    ds_read_b128 v[84:87], v1 offset:13312
    v_mfma_f32_16x16x32_bf16 v[52:55], v[112:115], v[148:151], v[52:55]
    v_mfma_f32_16x16x32_bf16 v[56:59], v[116:119], v[144:147], v[56:59]
    ds_read_b128 v[88:91], v1 offset:14336
    v_mfma_f32_16x16x32_bf16 v[60:63], v[116:119], v[148:151], v[60:63]
    s_waitcnt lgkmcnt(0)
    s_waitcnt vmcnt(6)
    s_barrier
    v_mfma_f32_16x16x32_bf16 v[8:11], v[64:67], v[120:123], v[8:11]
    ds_read_b128 v[92:95], v1 offset:16384
    v_mfma_f32_16x16x32_bf16 v[12:15], v[64:67], v[124:127], v[12:15]
    ds_read_b128 v[96:99], v1 offset:17408
    v_mfma_f32_16x16x32_bf16 v[16:19], v[68:71], v[120:123], v[16:19]
    v_mfma_f32_16x16x32_bf16 v[20:23], v[68:71], v[124:127], v[20:23]
    s_add_u32 s7, s54, 19456
    buffer_load_dwordx4 v[144:147], v1, s[36:39], s7 offen
    v_mfma_f32_16x16x32_bf16 v[24:27], v[72:75], v[120:123], v[24:27]
    ds_read_b128 v[100:103], v1 offset:18432
    v_mfma_f32_16x16x32_bf16 v[28:31], v[72:75], v[124:127], v[28:31]
    v_mfma_f32_16x16x32_bf16 v[32:35], v[76:79], v[120:123], v[32:35]
    ds_read_b128 v[104:107], v1 offset:19456
    v_mfma_f32_16x16x32_bf16 v[36:39], v[76:79], v[124:127], v[36:39]
    s_add_u32 s7, s54, 39936
    buffer_load_dwordx4 v[148:151], v1, s[36:39], s7 offen
    v_mfma_f32_16x16x32_bf16 v[40:43], v[80:83], v[120:123], v[40:43]
    v_mfma_f32_16x16x32_bf16 v[44:47], v[80:83], v[124:127], v[44:47]
    ds_read_b128 v[108:111], v1 offset:20480
    v_mfma_f32_16x16x32_bf16 v[48:51], v[84:87], v[120:123], v[48:51]
    ds_read_b128 v[112:115], v1 offset:21504
    v_mfma_f32_16x16x32_bf16 v[52:55], v[84:87], v[124:127], v[52:55]
    v_mfma_f32_16x16x32_bf16 v[56:59], v[88:91], v[120:123], v[56:59]
    ds_read_b128 v[116:119], v1 offset:22528
    v_mfma_f32_16x16x32_bf16 v[60:63], v[88:91], v[124:127], v[60:63]
    s_waitcnt lgkmcnt(0)
    s_waitcnt vmcnt(4)
    s_barrier
    v_mfma_f32_16x16x32_bf16 v[8:11], v[92:95], v[128:131], v[8:11]
    ds_read_b128 v[64:67], v1 offset:24576
    v_mfma_f32_16x16x32_bf16 v[12:15], v[92:95], v[132:135], v[12:15]
    v_mfma_f32_16x16x32_bf16 v[16:19], v[96:99], v[128:131], v[16:19]
    ds_read_b128 v[68:71], v1 offset:25600
    v_mfma_f32_16x16x32_bf16 v[20:23], v[96:99], v[132:135], v[20:23]
    v_mfma_f32_16x16x32_bf16 v[24:27], v[100:103], v[128:131], v[24:27]
    ds_read_b128 v[72:75], v1 offset:26624
    v_mfma_f32_16x16x32_bf16 v[28:31], v[100:103], v[132:135], v[28:31]
    v_mfma_f32_16x16x32_bf16 v[32:35], v[104:107], v[128:131], v[32:35]
    ds_read_b128 v[76:79], v1 offset:27648
    v_mfma_f32_16x16x32_bf16 v[36:39], v[104:107], v[132:135], v[36:39]
    v_mfma_f32_16x16x32_bf16 v[40:43], v[108:111], v[128:131], v[40:43]
    ds_read_b128 v[80:83], v1 offset:28672
    v_mfma_f32_16x16x32_bf16 v[44:47], v[108:111], v[132:135], v[44:47]
    v_mfma_f32_16x16x32_bf16 v[48:51], v[112:115], v[128:131], v[48:51]
    ds_read_b128 v[84:87], v1 offset:29696
    v_mfma_f32_16x16x32_bf16 v[52:55], v[112:115], v[132:135], v[52:55]
    v_mfma_f32_16x16x32_bf16 v[56:59], v[116:119], v[128:131], v[56:59]
    ds_read_b128 v[88:91], v1 offset:30720
    v_mfma_f32_16x16x32_bf16 v[60:63], v[116:119], v[132:135], v[60:63]
    s_waitcnt lgkmcnt(0)
    s_waitcnt vmcnt(2)
    s_barrier
    v_mfma_f32_16x16x32_bf16 v[8:11], v[64:67], v[136:139], v[8:11]
    ds_read_b128 v[92:95], v1 offset:32768
    v_mfma_f32_16x16x32_bf16 v[12:15], v[64:67], v[140:143], v[12:15]
    v_mfma_f32_16x16x32_bf16 v[16:19], v[68:71], v[136:139], v[16:19]
    ds_read_b128 v[96:99], v1 offset:33792
    v_mfma_f32_16x16x32_bf16 v[20:23], v[68:71], v[140:143], v[20:23]
    v_mfma_f32_16x16x32_bf16 v[24:27], v[72:75], v[136:139], v[24:27]
    ds_read_b128 v[100:103], v1 offset:34816
    v_mfma_f32_16x16x32_bf16 v[28:31], v[72:75], v[140:143], v[28:31]
    v_mfma_f32_16x16x32_bf16 v[32:35], v[76:79], v[136:139], v[32:35]
    ds_read_b128 v[104:107], v1 offset:35840
    v_mfma_f32_16x16x32_bf16 v[36:39], v[76:79], v[140:143], v[36:39]
    v_mfma_f32_16x16x32_bf16 v[40:43], v[80:83], v[136:139], v[40:43]
    ds_read_b128 v[108:111], v1 offset:36864
    v_mfma_f32_16x16x32_bf16 v[44:47], v[80:83], v[140:143], v[44:47]
    v_mfma_f32_16x16x32_bf16 v[48:51], v[84:87], v[136:139], v[48:51]
    ds_read_b128 v[112:115], v1 offset:37888
    v_mfma_f32_16x16x32_bf16 v[52:55], v[84:87], v[140:143], v[52:55]
    v_mfma_f32_16x16x32_bf16 v[56:59], v[88:91], v[136:139], v[56:59]
    ds_read_b128 v[116:119], v1 offset:38912
    v_mfma_f32_16x16x32_bf16 v[60:63], v[88:91], v[140:143], v[60:63]
    s_waitcnt lgkmcnt(0)
    s_waitcnt vmcnt(0)
    v_mfma_f32_16x16x32_bf16 v[8:11], v[92:95], v[144:147], v[8:11]
    v_mfma_f32_16x16x32_bf16 v[12:15], v[92:95], v[148:151], v[12:15]
    v_mfma_f32_16x16x32_bf16 v[16:19], v[96:99], v[144:147], v[16:19]
    v_mfma_f32_16x16x32_bf16 v[20:23], v[96:99], v[148:151], v[20:23]
    v_mfma_f32_16x16x32_bf16 v[24:27], v[100:103], v[144:147], v[24:27]
    v_mfma_f32_16x16x32_bf16 v[28:31], v[100:103], v[148:151], v[28:31]
    v_mfma_f32_16x16x32_bf16 v[32:35], v[104:107], v[144:147], v[32:35]
    v_mfma_f32_16x16x32_bf16 v[36:39], v[104:107], v[148:151], v[36:39]
    v_mfma_f32_16x16x32_bf16 v[40:43], v[108:111], v[144:147], v[40:43]
    v_mfma_f32_16x16x32_bf16 v[44:47], v[108:111], v[148:151], v[44:47]
    v_mfma_f32_16x16x32_bf16 v[48:51], v[112:115], v[144:147], v[48:51]
    v_mfma_f32_16x16x32_bf16 v[52:55], v[112:115], v[148:151], v[52:55]
    v_mfma_f32_16x16x32_bf16 v[56:59], v[116:119], v[144:147], v[56:59]
    v_mfma_f32_16x16x32_bf16 v[60:63], v[116:119], v[148:151], v[60:63]
    v_lshrrev_b32 v6, 5, v0
    v_lshlrev_b32 v6, 8, v6
    v_and_b32 v7, 15, v0
    v_lshl_add_u32 v6, v7, 4, v6
    v_bfe_u32 v7, v0, 4, 1
    v_lshl_add_u32 v6, v7, 3, v6
    s_lshl_b32 s6, s5, 3
    s_lshl_b32 s7, s3, 1
    s_add_u32 s6, s6, s7
    s_mul_i32 s6, s6, 55296
    s_lshl_b32 s7, s4, 9
    s_add_u32 s6, s6, s7
    s_add_u32 s6, s6, 15441920
    s_add_u32 s7, s6, 55296
    s_lshl_b32 s41, s45, 9
    s_add_u32 s40, s6, s41
    s_add_u32 s41, s7, s41
    s_mov_b32 s42, 0x3fb8aa3b
    s_mov_b32 s43, 0x3fb8aa3b
    s_mov_b32 s44, 0x41a00000
    s_mov_b32 s46, 2.0
    s_mov_b32 s47, 2.0
    s_nop 4
    v_lshlrev_b32 v64, 16, v152
    v_and_b32 v65, 0xffff0000, v152
    v_lshlrev_b32 v66, 16, v153
    v_and_b32 v67, 0xffff0000, v153
    v_pk_add_f32 v[68:69], v[8:9], v[64:65]
    v_pk_add_f32 v[70:71], v[10:11], v[66:67]
    v_pk_add_f32 v[84:85], v[12:13], v[64:65]
    v_pk_add_f32 v[86:87], v[14:15], v[66:67]
    v_min_f32 v72, s44, v68
    v_min_f32 v73, s44, v69
    v_min_f32 v74, s44, v70
    v_min_f32 v75, s44, v71
    v_min_f32 v88, s44, v84
    v_min_f32 v89, s44, v85
    v_min_f32 v90, s44, v86
    v_min_f32 v91, s44, v87
    v_pk_mul_f32 v[72:73], v[72:73], s[42:43]
    v_pk_mul_f32 v[74:75], v[74:75], s[42:43]
    v_pk_mul_f32 v[88:89], v[88:89], s[42:43]
    v_pk_mul_f32 v[90:91], v[90:91], s[42:43]
    v_exp_f32 v72, v72
    v_exp_f32 v73, v73
    v_exp_f32 v74, v74
    v_exp_f32 v75, v75
    v_exp_f32 v88, v88
    v_exp_f32 v89, v89
    v_exp_f32 v90, v90
    v_exp_f32 v91, v91
    v_pk_add_f32 v[76:77], v[72:73], s[46:47]
    v_pk_add_f32 v[78:79], v[74:75], s[46:47]
    v_pk_add_f32 v[92:93], v[88:89], s[46:47]
    v_pk_add_f32 v[94:95], v[90:91], s[46:47]
    v_pk_mul_f32 v[76:77], v[76:77], v[72:73]
    v_pk_mul_f32 v[78:79], v[78:79], v[74:75]
    v_pk_mul_f32 v[92:93], v[92:93], v[88:89]
    v_pk_mul_f32 v[94:95], v[94:95], v[90:91]
    v_pk_add_f32 v[80:81], v[76:77], s[46:47]
    v_pk_add_f32 v[82:83], v[78:79], s[46:47]
    v_pk_add_f32 v[96:97], v[92:93], s[46:47]
    v_pk_add_f32 v[98:99], v[94:95], s[46:47]
    v_rcp_f32 v80, v80
    v_rcp_f32 v81, v81
    v_rcp_f32 v82, v82
    v_rcp_f32 v83, v83
    v_rcp_f32 v96, v96
    v_rcp_f32 v97, v97
    v_rcp_f32 v98, v98
    v_rcp_f32 v99, v99
    v_pk_mul_f32 v[76:77], v[76:77], v[68:69]
    v_pk_mul_f32 v[78:79], v[78:79], v[70:71]
    v_pk_mul_f32 v[92:93], v[92:93], v[84:85]
    v_pk_mul_f32 v[94:95], v[94:95], v[86:87]
    v_pk_mul_f32 v[76:77], v[76:77], v[80:81]
    v_pk_mul_f32 v[78:79], v[78:79], v[82:83]
    v_pk_mul_f32 v[92:93], v[92:93], v[96:97]
    v_pk_mul_f32 v[94:95], v[94:95], v[98:99]
    v_cvt_pk_bf16_f32 v100, v76, v77
    v_cvt_pk_bf16_f32 v101, v78, v79
    buffer_store_dwordx2 v[100:101], v6, s[36:39], s6 offen offset:0 sc0 sc1
    v_cvt_pk_bf16_f32 v102, v92, v93
    v_cvt_pk_bf16_f32 v103, v94, v95
    buffer_store_dwordx2 v[102:103], v6, s[36:39], s7 offen offset:0 sc0 sc1
    v_lshlrev_b32 v64, 16, v154
    v_and_b32 v65, 0xffff0000, v154
    v_lshlrev_b32 v66, 16, v155
    v_and_b32 v67, 0xffff0000, v155
    v_pk_add_f32 v[68:69], v[16:17], v[64:65]
    v_pk_add_f32 v[70:71], v[18:19], v[66:67]
    v_pk_add_f32 v[84:85], v[20:21], v[64:65]
    v_pk_add_f32 v[86:87], v[22:23], v[66:67]
    v_min_f32 v72, s44, v68
    v_min_f32 v73, s44, v69
    v_min_f32 v74, s44, v70
    v_min_f32 v75, s44, v71
    v_min_f32 v88, s44, v84
    v_min_f32 v89, s44, v85
    v_min_f32 v90, s44, v86
    v_min_f32 v91, s44, v87
    v_pk_mul_f32 v[72:73], v[72:73], s[42:43]
    v_pk_mul_f32 v[74:75], v[74:75], s[42:43]
    v_pk_mul_f32 v[88:89], v[88:89], s[42:43]
    v_pk_mul_f32 v[90:91], v[90:91], s[42:43]
    v_exp_f32 v72, v72
    v_exp_f32 v73, v73
    v_exp_f32 v74, v74
    v_exp_f32 v75, v75
    v_exp_f32 v88, v88
    v_exp_f32 v89, v89
    v_exp_f32 v90, v90
    v_exp_f32 v91, v91
    v_pk_add_f32 v[76:77], v[72:73], s[46:47]
    v_pk_add_f32 v[78:79], v[74:75], s[46:47]
    v_pk_add_f32 v[92:93], v[88:89], s[46:47]
    v_pk_add_f32 v[94:95], v[90:91], s[46:47]
    v_pk_mul_f32 v[76:77], v[76:77], v[72:73]
    v_pk_mul_f32 v[78:79], v[78:79], v[74:75]
    v_pk_mul_f32 v[92:93], v[92:93], v[88:89]
    v_pk_mul_f32 v[94:95], v[94:95], v[90:91]
    v_pk_add_f32 v[80:81], v[76:77], s[46:47]
    v_pk_add_f32 v[82:83], v[78:79], s[46:47]
    v_pk_add_f32 v[96:97], v[92:93], s[46:47]
    v_pk_add_f32 v[98:99], v[94:95], s[46:47]
    v_rcp_f32 v80, v80
    v_rcp_f32 v81, v81
    v_rcp_f32 v82, v82
    v_rcp_f32 v83, v83
    v_rcp_f32 v96, v96
    v_rcp_f32 v97, v97
    v_rcp_f32 v98, v98
    v_rcp_f32 v99, v99
    v_pk_mul_f32 v[76:77], v[76:77], v[68:69]
    v_pk_mul_f32 v[78:79], v[78:79], v[70:71]
    v_pk_mul_f32 v[92:93], v[92:93], v[84:85]
    v_pk_mul_f32 v[94:95], v[94:95], v[86:87]
    v_pk_mul_f32 v[76:77], v[76:77], v[80:81]
    v_pk_mul_f32 v[78:79], v[78:79], v[82:83]
    v_pk_mul_f32 v[92:93], v[92:93], v[96:97]
    v_pk_mul_f32 v[94:95], v[94:95], v[98:99]
    v_cvt_pk_bf16_f32 v104, v76, v77
    v_cvt_pk_bf16_f32 v105, v78, v79
    buffer_store_dwordx2 v[104:105], v6, s[36:39], s6 offen offset:512 sc0 sc1
    v_cvt_pk_bf16_f32 v106, v92, v93
    v_cvt_pk_bf16_f32 v107, v94, v95
    buffer_store_dwordx2 v[106:107], v6, s[36:39], s7 offen offset:512 sc0 sc1
    v_lshlrev_b32 v64, 16, v156
    v_and_b32 v65, 0xffff0000, v156
    v_lshlrev_b32 v66, 16, v157
    v_and_b32 v67, 0xffff0000, v157
    v_pk_add_f32 v[68:69], v[24:25], v[64:65]
    v_pk_add_f32 v[70:71], v[26:27], v[66:67]
    v_pk_add_f32 v[84:85], v[28:29], v[64:65]
    v_pk_add_f32 v[86:87], v[30:31], v[66:67]
    v_min_f32 v72, s44, v68
    v_min_f32 v73, s44, v69
    v_min_f32 v74, s44, v70
    v_min_f32 v75, s44, v71
    v_min_f32 v88, s44, v84
    v_min_f32 v89, s44, v85
    v_min_f32 v90, s44, v86
    v_min_f32 v91, s44, v87
    v_pk_mul_f32 v[72:73], v[72:73], s[42:43]
    v_pk_mul_f32 v[74:75], v[74:75], s[42:43]
    v_pk_mul_f32 v[88:89], v[88:89], s[42:43]
    v_pk_mul_f32 v[90:91], v[90:91], s[42:43]
    v_exp_f32 v72, v72
    v_exp_f32 v73, v73
    v_exp_f32 v74, v74
    v_exp_f32 v75, v75
    v_exp_f32 v88, v88
    v_exp_f32 v89, v89
    v_exp_f32 v90, v90
    v_exp_f32 v91, v91
    v_pk_add_f32 v[76:77], v[72:73], s[46:47]
    v_pk_add_f32 v[78:79], v[74:75], s[46:47]
    v_pk_add_f32 v[92:93], v[88:89], s[46:47]
    v_pk_add_f32 v[94:95], v[90:91], s[46:47]
    v_pk_mul_f32 v[76:77], v[76:77], v[72:73]
    v_pk_mul_f32 v[78:79], v[78:79], v[74:75]
    v_pk_mul_f32 v[92:93], v[92:93], v[88:89]
    v_pk_mul_f32 v[94:95], v[94:95], v[90:91]
    v_pk_add_f32 v[80:81], v[76:77], s[46:47]
    v_pk_add_f32 v[82:83], v[78:79], s[46:47]
    v_pk_add_f32 v[96:97], v[92:93], s[46:47]
    v_pk_add_f32 v[98:99], v[94:95], s[46:47]
    v_rcp_f32 v80, v80
    v_rcp_f32 v81, v81
    v_rcp_f32 v82, v82
    v_rcp_f32 v83, v83
    v_rcp_f32 v96, v96
    v_rcp_f32 v97, v97
    v_rcp_f32 v98, v98
    v_rcp_f32 v99, v99
    v_pk_mul_f32 v[76:77], v[76:77], v[68:69]
    v_pk_mul_f32 v[78:79], v[78:79], v[70:71]
    v_pk_mul_f32 v[92:93], v[92:93], v[84:85]
    v_pk_mul_f32 v[94:95], v[94:95], v[86:87]
    v_pk_mul_f32 v[76:77], v[76:77], v[80:81]
    v_pk_mul_f32 v[78:79], v[78:79], v[82:83]
    v_pk_mul_f32 v[92:93], v[92:93], v[96:97]
    v_pk_mul_f32 v[94:95], v[94:95], v[98:99]
    v_cvt_pk_bf16_f32 v108, v76, v77
    v_cvt_pk_bf16_f32 v109, v78, v79
    buffer_store_dwordx2 v[108:109], v6, s[36:39], s6 offen offset:1024 sc0 sc1
    v_cvt_pk_bf16_f32 v110, v92, v93
    v_cvt_pk_bf16_f32 v111, v94, v95
    buffer_store_dwordx2 v[110:111], v6, s[36:39], s7 offen offset:1024 sc0 sc1
    v_lshlrev_b32 v64, 16, v158
    v_and_b32 v65, 0xffff0000, v158
    v_lshlrev_b32 v66, 16, v159
    v_and_b32 v67, 0xffff0000, v159
    v_pk_add_f32 v[68:69], v[32:33], v[64:65]
    v_pk_add_f32 v[70:71], v[34:35], v[66:67]
    v_pk_add_f32 v[84:85], v[36:37], v[64:65]
    v_pk_add_f32 v[86:87], v[38:39], v[66:67]
    v_min_f32 v72, s44, v68
    v_min_f32 v73, s44, v69
    v_min_f32 v74, s44, v70
    v_min_f32 v75, s44, v71
    v_min_f32 v88, s44, v84
    v_min_f32 v89, s44, v85
    v_min_f32 v90, s44, v86
    v_min_f32 v91, s44, v87
    v_pk_mul_f32 v[72:73], v[72:73], s[42:43]
    v_pk_mul_f32 v[74:75], v[74:75], s[42:43]
    v_pk_mul_f32 v[88:89], v[88:89], s[42:43]
    v_pk_mul_f32 v[90:91], v[90:91], s[42:43]
    v_exp_f32 v72, v72
    v_exp_f32 v73, v73
    v_exp_f32 v74, v74
    v_exp_f32 v75, v75
    v_exp_f32 v88, v88
    v_exp_f32 v89, v89
    v_exp_f32 v90, v90
    v_exp_f32 v91, v91
    v_pk_add_f32 v[76:77], v[72:73], s[46:47]
    v_pk_add_f32 v[78:79], v[74:75], s[46:47]
    v_pk_add_f32 v[92:93], v[88:89], s[46:47]
    v_pk_add_f32 v[94:95], v[90:91], s[46:47]
    v_pk_mul_f32 v[76:77], v[76:77], v[72:73]
    v_pk_mul_f32 v[78:79], v[78:79], v[74:75]
    v_pk_mul_f32 v[92:93], v[92:93], v[88:89]
    v_pk_mul_f32 v[94:95], v[94:95], v[90:91]
    v_pk_add_f32 v[80:81], v[76:77], s[46:47]
    v_pk_add_f32 v[82:83], v[78:79], s[46:47]
    v_pk_add_f32 v[96:97], v[92:93], s[46:47]
    v_pk_add_f32 v[98:99], v[94:95], s[46:47]
    v_rcp_f32 v80, v80
    v_rcp_f32 v81, v81
    v_rcp_f32 v82, v82
    v_rcp_f32 v83, v83
    v_rcp_f32 v96, v96
    v_rcp_f32 v97, v97
    v_rcp_f32 v98, v98
    v_rcp_f32 v99, v99
    v_pk_mul_f32 v[76:77], v[76:77], v[68:69]
    v_pk_mul_f32 v[78:79], v[78:79], v[70:71]
    v_pk_mul_f32 v[92:93], v[92:93], v[84:85]
    v_pk_mul_f32 v[94:95], v[94:95], v[86:87]
    v_pk_mul_f32 v[76:77], v[76:77], v[80:81]
    v_pk_mul_f32 v[78:79], v[78:79], v[82:83]
    v_pk_mul_f32 v[92:93], v[92:93], v[96:97]
    v_pk_mul_f32 v[94:95], v[94:95], v[98:99]
    v_cvt_pk_bf16_f32 v112, v76, v77
    v_cvt_pk_bf16_f32 v113, v78, v79
    buffer_store_dwordx2 v[112:113], v6, s[36:39], s6 offen offset:1536 sc0 sc1
    v_cvt_pk_bf16_f32 v114, v92, v93
    v_cvt_pk_bf16_f32 v115, v94, v95
    buffer_store_dwordx2 v[114:115], v6, s[36:39], s7 offen offset:1536 sc0 sc1
    v_lshlrev_b32 v64, 16, v160
    v_and_b32 v65, 0xffff0000, v160
    v_lshlrev_b32 v66, 16, v161
    v_and_b32 v67, 0xffff0000, v161
    v_pk_add_f32 v[68:69], v[40:41], v[64:65]
    v_pk_add_f32 v[70:71], v[42:43], v[66:67]
    v_pk_add_f32 v[84:85], v[44:45], v[64:65]
    v_pk_add_f32 v[86:87], v[46:47], v[66:67]
    v_min_f32 v72, s44, v68
    v_min_f32 v73, s44, v69
    v_min_f32 v74, s44, v70
    v_min_f32 v75, s44, v71
    v_min_f32 v88, s44, v84
    v_min_f32 v89, s44, v85
    v_min_f32 v90, s44, v86
    v_min_f32 v91, s44, v87
    v_pk_mul_f32 v[72:73], v[72:73], s[42:43]
    v_pk_mul_f32 v[74:75], v[74:75], s[42:43]
    v_pk_mul_f32 v[88:89], v[88:89], s[42:43]
    v_pk_mul_f32 v[90:91], v[90:91], s[42:43]
    v_exp_f32 v72, v72
    v_exp_f32 v73, v73
    v_exp_f32 v74, v74
    v_exp_f32 v75, v75
    v_exp_f32 v88, v88
    v_exp_f32 v89, v89
    v_exp_f32 v90, v90
    v_exp_f32 v91, v91
    v_pk_add_f32 v[76:77], v[72:73], s[46:47]
    v_pk_add_f32 v[78:79], v[74:75], s[46:47]
    v_pk_add_f32 v[92:93], v[88:89], s[46:47]
    v_pk_add_f32 v[94:95], v[90:91], s[46:47]
    v_pk_mul_f32 v[76:77], v[76:77], v[72:73]
    v_pk_mul_f32 v[78:79], v[78:79], v[74:75]
    v_pk_mul_f32 v[92:93], v[92:93], v[88:89]
    v_pk_mul_f32 v[94:95], v[94:95], v[90:91]
    v_pk_add_f32 v[80:81], v[76:77], s[46:47]
    v_pk_add_f32 v[82:83], v[78:79], s[46:47]
    v_pk_add_f32 v[96:97], v[92:93], s[46:47]
    v_pk_add_f32 v[98:99], v[94:95], s[46:47]
    v_rcp_f32 v80, v80
    v_rcp_f32 v81, v81
    v_rcp_f32 v82, v82
    v_rcp_f32 v83, v83
    v_rcp_f32 v96, v96
    v_rcp_f32 v97, v97
    v_rcp_f32 v98, v98
    v_rcp_f32 v99, v99
    v_pk_mul_f32 v[76:77], v[76:77], v[68:69]
    v_pk_mul_f32 v[78:79], v[78:79], v[70:71]
    v_pk_mul_f32 v[92:93], v[92:93], v[84:85]
    v_pk_mul_f32 v[94:95], v[94:95], v[86:87]
    v_pk_mul_f32 v[76:77], v[76:77], v[80:81]
    v_pk_mul_f32 v[78:79], v[78:79], v[82:83]
    v_pk_mul_f32 v[92:93], v[92:93], v[96:97]
    v_pk_mul_f32 v[94:95], v[94:95], v[98:99]
    v_cvt_pk_bf16_f32 v100, v76, v77
    v_cvt_pk_bf16_f32 v101, v78, v79
    buffer_store_dwordx2 v[100:101], v6, s[36:39], s6 offen offset:2048 sc0 sc1
    v_cvt_pk_bf16_f32 v102, v92, v93
    v_cvt_pk_bf16_f32 v103, v94, v95
    buffer_store_dwordx2 v[102:103], v6, s[36:39], s7 offen offset:2048 sc0 sc1
    v_lshlrev_b32 v64, 16, v162
    v_and_b32 v65, 0xffff0000, v162
    v_lshlrev_b32 v66, 16, v163
    v_and_b32 v67, 0xffff0000, v163
    v_pk_add_f32 v[68:69], v[48:49], v[64:65]
    v_pk_add_f32 v[70:71], v[50:51], v[66:67]
    v_pk_add_f32 v[84:85], v[52:53], v[64:65]
    v_pk_add_f32 v[86:87], v[54:55], v[66:67]
    v_min_f32 v72, s44, v68
    v_min_f32 v73, s44, v69
    v_min_f32 v74, s44, v70
    v_min_f32 v75, s44, v71
    v_min_f32 v88, s44, v84
    v_min_f32 v89, s44, v85
    v_min_f32 v90, s44, v86
    v_min_f32 v91, s44, v87
    v_pk_mul_f32 v[72:73], v[72:73], s[42:43]
    v_pk_mul_f32 v[74:75], v[74:75], s[42:43]
    v_pk_mul_f32 v[88:89], v[88:89], s[42:43]
    v_pk_mul_f32 v[90:91], v[90:91], s[42:43]
    v_exp_f32 v72, v72
    v_exp_f32 v73, v73
    v_exp_f32 v74, v74
    v_exp_f32 v75, v75
    v_exp_f32 v88, v88
    v_exp_f32 v89, v89
    v_exp_f32 v90, v90
    v_exp_f32 v91, v91
    v_pk_add_f32 v[76:77], v[72:73], s[46:47]
    v_pk_add_f32 v[78:79], v[74:75], s[46:47]
    v_pk_add_f32 v[92:93], v[88:89], s[46:47]
    v_pk_add_f32 v[94:95], v[90:91], s[46:47]
    v_pk_mul_f32 v[76:77], v[76:77], v[72:73]
    v_pk_mul_f32 v[78:79], v[78:79], v[74:75]
    v_pk_mul_f32 v[92:93], v[92:93], v[88:89]
    v_pk_mul_f32 v[94:95], v[94:95], v[90:91]
    v_pk_add_f32 v[80:81], v[76:77], s[46:47]
    v_pk_add_f32 v[82:83], v[78:79], s[46:47]
    v_pk_add_f32 v[96:97], v[92:93], s[46:47]
    v_pk_add_f32 v[98:99], v[94:95], s[46:47]
    v_rcp_f32 v80, v80
    v_rcp_f32 v81, v81
    v_rcp_f32 v82, v82
    v_rcp_f32 v83, v83
    v_rcp_f32 v96, v96
    v_rcp_f32 v97, v97
    v_rcp_f32 v98, v98
    v_rcp_f32 v99, v99
    v_pk_mul_f32 v[76:77], v[76:77], v[68:69]
    v_pk_mul_f32 v[78:79], v[78:79], v[70:71]
    v_pk_mul_f32 v[92:93], v[92:93], v[84:85]
    v_pk_mul_f32 v[94:95], v[94:95], v[86:87]
    v_pk_mul_f32 v[76:77], v[76:77], v[80:81]
    v_pk_mul_f32 v[78:79], v[78:79], v[82:83]
    v_pk_mul_f32 v[92:93], v[92:93], v[96:97]
    v_pk_mul_f32 v[94:95], v[94:95], v[98:99]
    v_cvt_pk_bf16_f32 v104, v76, v77
    v_cvt_pk_bf16_f32 v105, v78, v79
    buffer_store_dwordx2 v[104:105], v6, s[36:39], s6 offen offset:2560 sc0 sc1
    v_cvt_pk_bf16_f32 v106, v92, v93
    v_cvt_pk_bf16_f32 v107, v94, v95
    buffer_store_dwordx2 v[106:107], v6, s[36:39], s7 offen offset:2560 sc0 sc1
    v_lshlrev_b32 v64, 16, v164
    v_and_b32 v65, 0xffff0000, v164
    v_lshlrev_b32 v66, 16, v165
    v_and_b32 v67, 0xffff0000, v165
    v_pk_add_f32 v[68:69], v[56:57], v[64:65]
    v_pk_add_f32 v[70:71], v[58:59], v[66:67]
    v_pk_add_f32 v[84:85], v[60:61], v[64:65]
    v_pk_add_f32 v[86:87], v[62:63], v[66:67]
    v_min_f32 v72, s44, v68
    v_min_f32 v73, s44, v69
    v_min_f32 v74, s44, v70
    v_min_f32 v75, s44, v71
    v_min_f32 v88, s44, v84
    v_min_f32 v89, s44, v85
    v_min_f32 v90, s44, v86
    v_min_f32 v91, s44, v87
    v_pk_mul_f32 v[72:73], v[72:73], s[42:43]
    v_pk_mul_f32 v[74:75], v[74:75], s[42:43]
    v_pk_mul_f32 v[88:89], v[88:89], s[42:43]
    v_pk_mul_f32 v[90:91], v[90:91], s[42:43]
    v_exp_f32 v72, v72
    v_exp_f32 v73, v73
    v_exp_f32 v74, v74
    v_exp_f32 v75, v75
    v_exp_f32 v88, v88
    v_exp_f32 v89, v89
    v_exp_f32 v90, v90
    v_exp_f32 v91, v91
    v_pk_add_f32 v[76:77], v[72:73], s[46:47]
    v_pk_add_f32 v[78:79], v[74:75], s[46:47]
    v_pk_add_f32 v[92:93], v[88:89], s[46:47]
    v_pk_add_f32 v[94:95], v[90:91], s[46:47]
    v_pk_mul_f32 v[76:77], v[76:77], v[72:73]
    v_pk_mul_f32 v[78:79], v[78:79], v[74:75]
    v_pk_mul_f32 v[92:93], v[92:93], v[88:89]
    v_pk_mul_f32 v[94:95], v[94:95], v[90:91]
    v_pk_add_f32 v[80:81], v[76:77], s[46:47]
    v_pk_add_f32 v[82:83], v[78:79], s[46:47]
    v_pk_add_f32 v[96:97], v[92:93], s[46:47]
    v_pk_add_f32 v[98:99], v[94:95], s[46:47]
    v_rcp_f32 v80, v80
    v_rcp_f32 v81, v81
    v_rcp_f32 v82, v82
    v_rcp_f32 v83, v83
    v_rcp_f32 v96, v96
    v_rcp_f32 v97, v97
    v_rcp_f32 v98, v98
    v_rcp_f32 v99, v99
    v_pk_mul_f32 v[76:77], v[76:77], v[68:69]
    v_pk_mul_f32 v[78:79], v[78:79], v[70:71]
    v_pk_mul_f32 v[92:93], v[92:93], v[84:85]
    v_pk_mul_f32 v[94:95], v[94:95], v[86:87]
    v_pk_mul_f32 v[76:77], v[76:77], v[80:81]
    v_pk_mul_f32 v[78:79], v[78:79], v[82:83]
    v_pk_mul_f32 v[92:93], v[92:93], v[96:97]
    v_pk_mul_f32 v[94:95], v[94:95], v[98:99]
    v_cvt_pk_bf16_f32 v108, v76, v77
    v_cvt_pk_bf16_f32 v109, v78, v79
    buffer_store_dwordx2 v[108:109], v6, s[36:39], s40 offen offset:0 sc0 sc1
    v_cvt_pk_bf16_f32 v110, v92, v93
    v_cvt_pk_bf16_f32 v111, v94, v95
    buffer_store_dwordx2 v[110:111], v6, s[36:39], s41 offen offset:0 sc0 sc1
    s_branch L_end_p2
L_end_p2:
    s_endpgm
.globl fin_kernel
.p2align 8
.type fin_kernel,@function
fin_kernel:
    s_cmp_ge_u32 s2, 256
    s_cbranch_scc1 L_end_p3
    s_load_dwordx16 s[8:23], s[0:1], 0
    s_load_dwordx8 s[24:31], s[0:1], 64
    s_load_dwordx4 s[32:35], s[0:1], 96
    v_lshrrev_b32 v1, 6, v0
    v_and_b32 v0, 63, v0
    s_nop 0
    v_readfirstlane_b32 s3, v1
    s_waitcnt lgkmcnt(0)
    s_mov_b32 s36, s34
    s_and_b32 s37, s35, 0xffff
    s_mov_b32 s38, 25141248
    s_mov_b32 s39, 0x00020000
    s_lshr_b32 s4, s2, 5
    s_and_b32 s5, s2, 7
    s_lshl_b32 s5, s5, 2
    s_bfe_u32 s6, s2, 0x20003
    s_add_u32 s5, s5, s6
    s_lshr_b32 s46, s3, 1
    s_and_b32 s40, s3, 1
    s_lshl_b32 s47, s40, 1
    s_add_u32 s47, s47, s46
    s_lshl_b32 s41, s5, 2
    s_lshl_b32 s40, s40, 1
    s_add_u32 s41, s41, s40
    s_mul_i32 s41, s41, 54
    s_add_u32 s41, s41, s46
    s_lshl_b32 s41, s41, 10
    s_add_u32 s54, s41, 15441920
    s_add_u32 s6, s3, 0
    s_lshl_b32 s56, s6, 10
    s_cmp_ge_u32 s6, 5
    s_cselect_b32 s40, 1, 0
    s_mul_i32 s41, s40, 5
    s_sub_u32 s41, s6, s41
    s_mul_i32 s42, s4, 5
    s_add_u32 s42, s42, s41
    s_mul_i32 s42, s42, 54
    s_add_u32 s42, s42, s40
    s_lshl_b32 s42, s42, 10
    s_add_u32 s48, s42, 7618560
    s_add_u32 s6, s3, 4
    s_lshl_b32 s57, s6, 10
    s_cmp_ge_u32 s6, 5
    s_cselect_b32 s40, 1, 0
    s_mul_i32 s41, s40, 5
    s_sub_u32 s41, s6, s41
    s_mul_i32 s42, s4, 5
    s_add_u32 s42, s42, s41
    s_mul_i32 s42, s42, 54
    s_add_u32 s42, s42, s40
    s_lshl_b32 s42, s42, 10
    s_add_u32 s49, s42, 7618560
    s_mul_i32 s7, s3, 512
    s_lshr_b32 s6, s7, 10
    s_add_u32 s6, s6, 8
    s_and_b32 s7, s7, 1023
    s_lshl_b32 s58, s6, 10
    s_add_u32 s58, s58, s7
    s_cmp_ge_u32 s6, 5
    s_cselect_b32 s40, 1, 0
    s_mul_i32 s41, s40, 5
    s_sub_u32 s41, s6, s41
    s_mul_i32 s42, s4, 5
    s_add_u32 s42, s42, s41
    s_mul_i32 s42, s42, 54
    s_add_u32 s42, s42, s40
    s_lshl_b32 s42, s42, 10
    s_add_u32 s50, s42, 7618560
    s_add_u32 s50, s50, s7
    v_lshlrev_b32 v1, 4, v0
    s_mul_i32 s6, s46, 5120
    v_add_u32 v2, s6, v1
    s_add_u32 m0, s56, 0
    s_add_u32 s6, s48, 0
    buffer_load_dwordx4 v1, s[36:39], s6 offen lds
    s_add_u32 m0, s57, 0
    s_add_u32 s6, s49, 0
    buffer_load_dwordx4 v1, s[36:39], s6 offen lds
    s_add_u32 m0, s58, 0
    s_add_u32 s6, s50, 0
    s_mov_b64 exec, 0xffffffff
    buffer_load_dwordx4 v1, s[36:39], s6 offen lds
    s_mov_b64 exec, -1
    s_add_u32 s7, s54, 0
    buffer_load_dwordx4 v[92:95], v1, s[36:39], s7 offen
    s_add_u32 s7, s54, 55296
    buffer_load_dwordx4 v[96:99], v1, s[36:39], s7 offen
    s_add_u32 m0, s56, 10240
    s_add_u32 s6, s48, 2048
    buffer_load_dwordx4 v1, s[36:39], s6 offen lds
    s_add_u32 m0, s57, 10240
    s_add_u32 s6, s49, 2048
    buffer_load_dwordx4 v1, s[36:39], s6 offen lds
    s_add_u32 m0, s58, 10240
    s_add_u32 s6, s50, 2048
    s_mov_b64 exec, 0xffffffff
    buffer_load_dwordx4 v1, s[36:39], s6 offen lds
    s_mov_b64 exec, -1
    s_add_u32 s7, s54, 2048
    buffer_load_dwordx4 v[100:103], v1, s[36:39], s7 offen
    s_add_u32 s7, s54, 57344
    buffer_load_dwordx4 v[104:107], v1, s[36:39], s7 offen
    s_add_u32 m0, s56, 20480
    s_add_u32 s6, s48, 4096
    buffer_load_dwordx4 v1, s[36:39], s6 offen lds
    s_add_u32 m0, s57, 20480
    s_add_u32 s6, s49, 4096
    buffer_load_dwordx4 v1, s[36:39], s6 offen lds
    s_add_u32 m0, s58, 20480
    s_add_u32 s6, s50, 4096
    s_mov_b64 exec, 0xffffffff
    buffer_load_dwordx4 v1, s[36:39], s6 offen lds
    s_mov_b64 exec, -1
    s_add_u32 s7, s54, 4096
    buffer_load_dwordx4 v[108:111], v1, s[36:39], s7 offen
    s_add_u32 s7, s54, 59392
    buffer_load_dwordx4 v[112:115], v1, s[36:39], s7 offen
    s_add_u32 m0, s56, 30720
    s_add_u32 s6, s48, 6144
    buffer_load_dwordx4 v1, s[36:39], s6 offen lds
    s_add_u32 m0, s57, 30720
    s_add_u32 s6, s49, 6144
    buffer_load_dwordx4 v1, s[36:39], s6 offen lds
    s_add_u32 m0, s58, 30720
    s_add_u32 s6, s50, 6144
    s_mov_b64 exec, 0xffffffff
    buffer_load_dwordx4 v1, s[36:39], s6 offen lds
    s_mov_b64 exec, -1
    s_add_u32 s7, s54, 6144
    buffer_load_dwordx4 v[116:119], v1, s[36:39], s7 offen
    s_add_u32 s7, s54, 61440
    buffer_load_dwordx4 v[120:123], v1, s[36:39], s7 offen
    s_add_u32 m0, s56, 40960
    s_add_u32 s6, s48, 8192
    buffer_load_dwordx4 v1, s[36:39], s6 offen lds
    s_add_u32 m0, s57, 40960
    s_add_u32 s6, s49, 8192
    buffer_load_dwordx4 v1, s[36:39], s6 offen lds
    s_add_u32 m0, s58, 40960
    s_add_u32 s6, s50, 8192
    s_mov_b64 exec, 0xffffffff
    buffer_load_dwordx4 v1, s[36:39], s6 offen lds
    s_mov_b64 exec, -1
    s_lshl_b32 s6, s5, 6
    s_lshl_b32 s7, s47, 4
    s_add_u32 s6, s6, s7
    v_and_b32 v6, 15, v0
    v_add_u32 v6, s6, v6
    v_lshrrev_b32 v7, 4, v0
    s_mul_i32 s7, s4, 160
    v_mul_u32_u24 v8, 1280, v6
    v_lshl_add_u32 v8, v7, 3, v8
    v_add_u32 v8, s7, v8
    v_lshlrev_b32 v9, 3, v7
    v_add_u32 v9, s7, v9
    v_lshrrev_b32 v10, 5, v0
    v_lshlrev_b32 v10, 8, v10
    v_and_b32 v11, 15, v0
    v_lshl_add_u32 v10, v11, 4, v10
    v_bfe_u32 v11, v0, 4, 1
    v_lshl_add_u32 v10, v11, 3, v10
    s_lshr_b32 s40, s6, 4
    s_mul_i32 s40, s40, 20480
    s_mul_i32 s41, s4, 2560
    s_add_u32 s40, s40, s41
    s_add_u32 s40, s40, 0
    v_lshlrev_b32 v11, 14, v7
    v_lshl_add_u32 v11, v6, 1, v11
    s_mul_i32 s41, s4, 327680
    s_add_u32 s41, s41, 22519808
    v_mov_b32 v12, 0
    v_mov_b32 v13, 0
    v_mov_b32 v14, 0
    v_mov_b32 v15, 0
    v_mov_b32 v16, 0
    v_mov_b32 v17, 0
    v_mov_b32 v18, 0
    v_mov_b32 v19, 0
    v_mov_b32 v20, 0
    v_mov_b32 v21, 0
    v_mov_b32 v22, 0
    v_mov_b32 v23, 0
    v_mov_b32 v24, 0
    v_mov_b32 v25, 0
    v_mov_b32 v26, 0
    v_mov_b32 v27, 0
    v_mov_b32 v28, 0
    v_mov_b32 v29, 0
    v_mov_b32 v30, 0
    v_mov_b32 v31, 0
    v_mov_b32 v32, 0
    v_mov_b32 v33, 0
    v_mov_b32 v34, 0
    v_mov_b32 v35, 0
    v_mov_b32 v36, 0
    v_mov_b32 v37, 0
    v_mov_b32 v38, 0
    v_mov_b32 v39, 0
    v_mov_b32 v40, 0
    v_mov_b32 v41, 0
    v_mov_b32 v42, 0
    v_mov_b32 v43, 0
    v_mov_b32 v44, 0
    v_mov_b32 v45, 0
    v_mov_b32 v46, 0
    v_mov_b32 v47, 0
    v_mov_b32 v48, 0
    v_mov_b32 v49, 0
    v_mov_b32 v50, 0
    v_mov_b32 v51, 0
    s_waitcnt vmcnt(20)
    s_barrier
    ds_read_b128 v[52:55], v2 offset:0
    ds_read_b128 v[56:59], v2 offset:1024
    ds_read_b128 v[60:63], v2 offset:2048
    ds_read_b128 v[64:67], v2 offset:3072
    ds_read_b128 v[68:71], v2 offset:4096
    s_waitcnt lgkmcnt(0)
    s_waitcnt vmcnt(15)
    s_barrier
    v_mfma_f32_16x16x32_bf16 v[12:15], v[52:55], v[92:95], v[12:15]
    ds_read_b128 v[72:75], v2 offset:10240
    v_mfma_f32_16x16x32_bf16 v[16:19], v[52:55], v[96:99], v[16:19]
    s_add_u32 m0, s56, 0
    s_add_u32 s6, s48, 10240
    buffer_load_dwordx4 v1, s[36:39], s6 offen lds
    v_mfma_f32_16x16x32_bf16 v[20:23], v[56:59], v[92:95], v[20:23]
    ds_read_b128 v[76:79], v2 offset:11264
    v_mfma_f32_16x16x32_bf16 v[24:27], v[56:59], v[96:99], v[24:27]
    s_add_u32 m0, s57, 0
    s_add_u32 s6, s49, 10240
    buffer_load_dwordx4 v1, s[36:39], s6 offen lds
    v_mfma_f32_16x16x32_bf16 v[28:31], v[60:63], v[92:95], v[28:31]
    ds_read_b128 v[80:83], v2 offset:12288
    v_mfma_f32_16x16x32_bf16 v[32:35], v[60:63], v[96:99], v[32:35]
    s_add_u32 m0, s58, 0
    s_add_u32 s6, s50, 10240
    s_mov_b64 exec, 0xffffffff
    buffer_load_dwordx4 v1, s[36:39], s6 offen lds
    s_mov_b64 exec, -1
    v_mfma_f32_16x16x32_bf16 v[36:39], v[64:67], v[92:95], v[36:39]
    ds_read_b128 v[84:87], v2 offset:13312
    v_mfma_f32_16x16x32_bf16 v[40:43], v[64:67], v[96:99], v[40:43]
    s_add_u32 s7, s54, 8192
    buffer_load_dwordx4 v[124:127], v1, s[36:39], s7 offen
    v_mfma_f32_16x16x32_bf16 v[44:47], v[68:71], v[92:95], v[44:47]
    ds_read_b128 v[88:91], v2 offset:14336
    v_mfma_f32_16x16x32_bf16 v[48:51], v[68:71], v[96:99], v[48:51]
    s_add_u32 s7, s54, 63488
    buffer_load_dwordx4 v[128:131], v1, s[36:39], s7 offen
    s_waitcnt lgkmcnt(0)
    s_waitcnt vmcnt(15)
    s_barrier
    v_mfma_f32_16x16x32_bf16 v[12:15], v[72:75], v[100:103], v[12:15]
    ds_read_b128 v[52:55], v2 offset:20480
    s_add_u32 m0, s56, 10240
    s_add_u32 s6, s48, 12288
    buffer_load_dwordx4 v1, s[36:39], s6 offen lds
    v_mfma_f32_16x16x32_bf16 v[16:19], v[72:75], v[104:107], v[16:19]
    ds_read_b128 v[56:59], v2 offset:21504
    v_mfma_f32_16x16x32_bf16 v[20:23], v[76:79], v[100:103], v[20:23]
    s_add_u32 m0, s57, 10240
    s_add_u32 s6, s49, 12288
    buffer_load_dwordx4 v1, s[36:39], s6 offen lds
    v_mfma_f32_16x16x32_bf16 v[24:27], v[76:79], v[104:107], v[24:27]
    ds_read_b128 v[60:63], v2 offset:22528
    v_mfma_f32_16x16x32_bf16 v[28:31], v[80:83], v[100:103], v[28:31]
    s_add_u32 m0, s58, 10240
    s_add_u32 s6, s50, 12288
    s_mov_b64 exec, 0xffffffff
    buffer_load_dwordx4 v1, s[36:39], s6 offen lds
    s_mov_b64 exec, -1
    v_mfma_f32_16x16x32_bf16 v[32:35], v[80:83], v[104:107], v[32:35]
    ds_read_b128 v[64:67], v2 offset:23552
    s_add_u32 s7, s54, 10240
    buffer_load_dwordx4 v[92:95], v1, s[36:39], s7 offen
    v_mfma_f32_16x16x32_bf16 v[36:39], v[84:87], v[100:103], v[36:39]
    ds_read_b128 v[68:71], v2 offset:24576
    v_mfma_f32_16x16x32_bf16 v[40:43], v[84:87], v[104:107], v[40:43]
    s_add_u32 s7, s54, 65536
    buffer_load_dwordx4 v[96:99], v1, s[36:39], s7 offen
    v_mfma_f32_16x16x32_bf16 v[44:47], v[88:91], v[100:103], v[44:47]
    global_load_dwordx2 v[132:133], v8, s[8:9] offset:0
    v_mfma_f32_16x16x32_bf16 v[48:51], v[88:91], v[104:107], v[48:51]
    global_load_dwordx2 v[152:153], v9, s[20:21] offset:0
    s_waitcnt lgkmcnt(0)
    s_waitcnt vmcnt(17)
    s_barrier
    v_mfma_f32_16x16x32_bf16 v[12:15], v[52:55], v[108:111], v[12:15]
    ds_read_b128 v[72:75], v2 offset:30720
    s_add_u32 m0, s56, 20480
    s_add_u32 s6, s48, 14336
    buffer_load_dwordx4 v1, s[36:39], s6 offen lds
    v_mfma_f32_16x16x32_bf16 v[16:19], v[52:55], v[112:115], v[16:19]
    ds_read_b128 v[76:79], v2 offset:31744
    v_mfma_f32_16x16x32_bf16 v[20:23], v[56:59], v[108:111], v[20:23]
    s_add_u32 m0, s57, 20480
    s_add_u32 s6, s49, 14336
    buffer_load_dwordx4 v1, s[36:39], s6 offen lds
    v_mfma_f32_16x16x32_bf16 v[24:27], v[56:59], v[112:115], v[24:27]
    ds_read_b128 v[80:83], v2 offset:32768
    v_mfma_f32_16x16x32_bf16 v[28:31], v[60:63], v[108:111], v[28:31]
    s_add_u32 m0, s58, 20480
    s_add_u32 s6, s50, 14336
    s_mov_b64 exec, 0xffffffff
    buffer_load_dwordx4 v1, s[36:39], s6 offen lds
    s_mov_b64 exec, -1
    v_mfma_f32_16x16x32_bf16 v[32:35], v[60:63], v[112:115], v[32:35]
    ds_read_b128 v[84:87], v2 offset:33792
    s_add_u32 s7, s54, 12288
    buffer_load_dwordx4 v[100:103], v1, s[36:39], s7 offen
    v_mfma_f32_16x16x32_bf16 v[36:39], v[64:67], v[108:111], v[36:39]
    ds_read_b128 v[88:91], v2 offset:34816
    v_mfma_f32_16x16x32_bf16 v[40:43], v[64:67], v[112:115], v[40:43]
    s_add_u32 s7, s54, 67584
    buffer_load_dwordx4 v[104:107], v1, s[36:39], s7 offen
    v_mfma_f32_16x16x32_bf16 v[44:47], v[68:71], v[108:111], v[44:47]
    buffer_load_dwordx2 v[142:143], v10, s[36:39], s40 offen offset:0
    v_mfma_f32_16x16x32_bf16 v[48:51], v[68:71], v[112:115], v[48:51]
    s_add_u32 s42, s41, 0
    buffer_load_ushort v164, v11, s[36:39], s42 offen
    s_waitcnt lgkmcnt(0)
    s_waitcnt vmcnt(19)
    s_barrier
    v_mfma_f32_16x16x32_bf16 v[12:15], v[72:75], v[116:119], v[12:15]
    ds_read_b128 v[52:55], v2 offset:40960
    s_add_u32 m0, s56, 30720
    s_add_u32 s6, s48, 16384
    buffer_load_dwordx4 v1, s[36:39], s6 offen lds
    v_mfma_f32_16x16x32_bf16 v[16:19], v[72:75], v[120:123], v[16:19]
    ds_read_b128 v[56:59], v2 offset:41984
    v_mfma_f32_16x16x32_bf16 v[20:23], v[76:79], v[116:119], v[20:23]
    s_add_u32 m0, s57, 30720
    s_add_u32 s6, s49, 16384
    buffer_load_dwordx4 v1, s[36:39], s6 offen lds
    v_mfma_f32_16x16x32_bf16 v[24:27], v[76:79], v[120:123], v[24:27]
    ds_read_b128 v[60:63], v2 offset:43008
    v_mfma_f32_16x16x32_bf16 v[28:31], v[80:83], v[116:119], v[28:31]
    s_add_u32 m0, s58, 30720
    s_add_u32 s6, s50, 16384
    s_mov_b64 exec, 0xffffffff
    buffer_load_dwordx4 v1, s[36:39], s6 offen lds
    s_mov_b64 exec, -1
    v_mfma_f32_16x16x32_bf16 v[32:35], v[80:83], v[120:123], v[32:35]
    ds_read_b128 v[64:67], v2 offset:44032
    s_add_u32 s7, s54, 14336
    buffer_load_dwordx4 v[108:111], v1, s[36:39], s7 offen
    v_mfma_f32_16x16x32_bf16 v[36:39], v[84:87], v[116:119], v[36:39]
    ds_read_b128 v[68:71], v2 offset:45056
    v_mfma_f32_16x16x32_bf16 v[40:43], v[84:87], v[120:123], v[40:43]
    s_add_u32 s7, s54, 69632
    buffer_load_dwordx4 v[112:115], v1, s[36:39], s7 offen
    v_mfma_f32_16x16x32_bf16 v[44:47], v[88:91], v[116:119], v[44:47]
    s_add_u32 s42, s41, 4096
    buffer_load_ushort v165, v11, s[36:39], s42 offen
    v_mfma_f32_16x16x32_bf16 v[48:51], v[88:91], v[120:123], v[48:51]
    s_add_u32 s42, s41, 8192
    buffer_load_ushort v166, v11, s[36:39], s42 offen
    s_waitcnt lgkmcnt(0)
    s_waitcnt vmcnt(21)
    s_barrier
    v_mfma_f32_16x16x32_bf16 v[12:15], v[52:55], v[124:127], v[12:15]
    ds_read_b128 v[72:75], v2 offset:0
    s_add_u32 m0, s56, 40960
    s_add_u32 s6, s48, 18432
    buffer_load_dwordx4 v1, s[36:39], s6 offen lds
    v_mfma_f32_16x16x32_bf16 v[16:19], v[52:55], v[128:131], v[16:19]
    ds_read_b128 v[76:79], v2 offset:1024
    v_mfma_f32_16x16x32_bf16 v[20:23], v[56:59], v[124:127], v[20:23]
    s_add_u32 m0, s57, 40960
    s_add_u32 s6, s49, 18432
    buffer_load_dwordx4 v1, s[36:39], s6 offen lds
    v_mfma_f32_16x16x32_bf16 v[24:27], v[56:59], v[128:131], v[24:27]
    ds_read_b128 v[80:83], v2 offset:2048
    v_mfma_f32_16x16x32_bf16 v[28:31], v[60:63], v[124:127], v[28:31]
    s_add_u32 m0, s58, 40960
    s_add_u32 s6, s50, 18432
    s_mov_b64 exec, 0xffffffff
    buffer_load_dwordx4 v1, s[36:39], s6 offen lds
    s_mov_b64 exec, -1
    v_mfma_f32_16x16x32_bf16 v[32:35], v[60:63], v[128:131], v[32:35]
    ds_read_b128 v[84:87], v2 offset:3072
    s_add_u32 s7, s54, 16384
    buffer_load_dwordx4 v[116:119], v1, s[36:39], s7 offen
    v_mfma_f32_16x16x32_bf16 v[36:39], v[64:67], v[124:127], v[36:39]
    ds_read_b128 v[88:91], v2 offset:4096
    v_mfma_f32_16x16x32_bf16 v[40:43], v[64:67], v[128:131], v[40:43]
    s_add_u32 s7, s54, 71680
    buffer_load_dwordx4 v[120:123], v1, s[36:39], s7 offen
    v_mfma_f32_16x16x32_bf16 v[44:47], v[68:71], v[124:127], v[44:47]
    s_add_u32 s42, s41, 12288
    buffer_load_ushort v167, v11, s[36:39], s42 offen
    v_mfma_f32_16x16x32_bf16 v[48:51], v[68:71], v[128:131], v[48:51]
    global_load_dwordx2 v[134:135], v8, s[8:9] offset:32
    s_waitcnt lgkmcnt(0)
    s_waitcnt vmcnt(23)
    s_barrier
    v_mfma_f32_16x16x32_bf16 v[12:15], v[72:75], v[92:95], v[12:15]
    ds_read_b128 v[52:55], v2 offset:10240
    s_add_u32 m0, s56, 0
    s_add_u32 s6, s48, 20480
    buffer_load_dwordx4 v1, s[36:39], s6 offen lds
    v_mfma_f32_16x16x32_bf16 v[16:19], v[72:75], v[96:99], v[16:19]
    ds_read_b128 v[56:59], v2 offset:11264
    v_mfma_f32_16x16x32_bf16 v[20:23], v[76:79], v[92:95], v[20:23]
    s_add_u32 m0, s57, 0
    s_add_u32 s6, s49, 20480
    buffer_load_dwordx4 v1, s[36:39], s6 offen lds
    v_mfma_f32_16x16x32_bf16 v[24:27], v[76:79], v[96:99], v[24:27]
    ds_read_b128 v[60:63], v2 offset:12288
    v_mfma_f32_16x16x32_bf16 v[28:31], v[80:83], v[92:95], v[28:31]
    s_add_u32 m0, s58, 0
    s_add_u32 s6, s50, 20480
    s_mov_b64 exec, 0xffffffff
    buffer_load_dwordx4 v1, s[36:39], s6 offen lds
    s_mov_b64 exec, -1
    v_mfma_f32_16x16x32_bf16 v[32:35], v[80:83], v[96:99], v[32:35]
    ds_read_b128 v[64:67], v2 offset:13312
    s_add_u32 s7, s54, 18432
    buffer_load_dwordx4 v[124:127], v1, s[36:39], s7 offen
    v_mfma_f32_16x16x32_bf16 v[36:39], v[84:87], v[92:95], v[36:39]
    ds_read_b128 v[68:71], v2 offset:14336
    v_mfma_f32_16x16x32_bf16 v[40:43], v[84:87], v[96:99], v[40:43]
    s_add_u32 s7, s54, 73728
    buffer_load_dwordx4 v[128:131], v1, s[36:39], s7 offen
    v_mfma_f32_16x16x32_bf16 v[44:47], v[88:91], v[92:95], v[44:47]
    global_load_dwordx2 v[154:155], v9, s[20:21] offset:32
    v_mfma_f32_16x16x32_bf16 v[48:51], v[88:91], v[96:99], v[48:51]
    buffer_load_dwordx2 v[144:145], v10, s[36:39], s40 offen offset:512
    s_waitcnt lgkmcnt(0)
    s_waitcnt vmcnt(23)
    s_barrier
    v_mfma_f32_16x16x32_bf16 v[12:15], v[52:55], v[100:103], v[12:15]
    ds_read_b128 v[72:75], v2 offset:20480
    s_add_u32 m0, s56, 10240
    s_add_u32 s6, s48, 22528
    buffer_load_dwordx4 v1, s[36:39], s6 offen lds
    v_mfma_f32_16x16x32_bf16 v[16:19], v[52:55], v[104:107], v[16:19]
    ds_read_b128 v[76:79], v2 offset:21504
    v_mfma_f32_16x16x32_bf16 v[20:23], v[56:59], v[100:103], v[20:23]
    s_add_u32 m0, s57, 10240
    s_add_u32 s6, s49, 22528
    buffer_load_dwordx4 v1, s[36:39], s6 offen lds
    v_mfma_f32_16x16x32_bf16 v[24:27], v[56:59], v[104:107], v[24:27]
    ds_read_b128 v[80:83], v2 offset:22528
    v_mfma_f32_16x16x32_bf16 v[28:31], v[60:63], v[100:103], v[28:31]
    s_add_u32 m0, s58, 10240
    s_add_u32 s6, s50, 22528
    s_mov_b64 exec, 0xffffffff
    buffer_load_dwordx4 v1, s[36:39], s6 offen lds
    s_mov_b64 exec, -1
    v_mfma_f32_16x16x32_bf16 v[32:35], v[60:63], v[104:107], v[32:35]
    ds_read_b128 v[84:87], v2 offset:23552
    s_add_u32 s7, s54, 20480
    buffer_load_dwordx4 v[92:95], v1, s[36:39], s7 offen
    v_mfma_f32_16x16x32_bf16 v[36:39], v[64:67], v[100:103], v[36:39]
    ds_read_b128 v[88:91], v2 offset:24576
    v_mfma_f32_16x16x32_bf16 v[40:43], v[64:67], v[104:107], v[40:43]
    s_add_u32 s7, s54, 75776
    buffer_load_dwordx4 v[96:99], v1, s[36:39], s7 offen
    v_mfma_f32_16x16x32_bf16 v[44:47], v[68:71], v[100:103], v[44:47]
    s_add_u32 s42, s41, 65536
    buffer_load_ushort v168, v11, s[36:39], s42 offen
    v_mfma_f32_16x16x32_bf16 v[48:51], v[68:71], v[104:107], v[48:51]
    s_add_u32 s42, s41, 69632
    buffer_load_ushort v169, v11, s[36:39], s42 offen
    s_waitcnt lgkmcnt(0)
    s_waitcnt vmcnt(23)
    s_barrier
    v_mfma_f32_16x16x32_bf16 v[12:15], v[72:75], v[108:111], v[12:15]
    ds_read_b128 v[52:55], v2 offset:30720
    s_add_u32 m0, s56, 20480
    s_add_u32 s6, s48, 24576
    buffer_load_dwordx4 v1, s[36:39], s6 offen lds
    v_mfma_f32_16x16x32_bf16 v[16:19], v[72:75], v[112:115], v[16:19]
    ds_read_b128 v[56:59], v2 offset:31744
    v_mfma_f32_16x16x32_bf16 v[20:23], v[76:79], v[108:111], v[20:23]
    s_add_u32 m0, s57, 20480
    s_add_u32 s6, s49, 24576
    buffer_load_dwordx4 v1, s[36:39], s6 offen lds
    v_mfma_f32_16x16x32_bf16 v[24:27], v[76:79], v[112:115], v[24:27]
    ds_read_b128 v[60:63], v2 offset:32768
    v_mfma_f32_16x16x32_bf16 v[28:31], v[80:83], v[108:111], v[28:31]
    s_add_u32 m0, s58, 20480
    s_add_u32 s6, s50, 24576
    s_mov_b64 exec, 0xffffffff
    buffer_load_dwordx4 v1, s[36:39], s6 offen lds
    s_mov_b64 exec, -1
    v_mfma_f32_16x16x32_bf16 v[32:35], v[80:83], v[112:115], v[32:35]
    ds_read_b128 v[64:67], v2 offset:33792
    s_add_u32 s7, s54, 22528
    buffer_load_dwordx4 v[100:103], v1, s[36:39], s7 offen
    v_mfma_f32_16x16x32_bf16 v[36:39], v[84:87], v[108:111], v[36:39]
    ds_read_b128 v[68:71], v2 offset:34816
    v_mfma_f32_16x16x32_bf16 v[40:43], v[84:87], v[112:115], v[40:43]
    s_add_u32 s7, s54, 77824
    buffer_load_dwordx4 v[104:107], v1, s[36:39], s7 offen
    v_mfma_f32_16x16x32_bf16 v[44:47], v[88:91], v[108:111], v[44:47]
    s_add_u32 s42, s41, 73728
    buffer_load_ushort v170, v11, s[36:39], s42 offen
    v_mfma_f32_16x16x32_bf16 v[48:51], v[88:91], v[112:115], v[48:51]
    s_add_u32 s42, s41, 77824
    buffer_load_ushort v171, v11, s[36:39], s42 offen
    s_waitcnt lgkmcnt(0)
    s_waitcnt vmcnt(23)
    s_barrier
    v_mfma_f32_16x16x32_bf16 v[12:15], v[52:55], v[116:119], v[12:15]
    ds_read_b128 v[72:75], v2 offset:40960
    s_add_u32 m0, s56, 30720
    s_add_u32 s6, s48, 26624
    buffer_load_dwordx4 v1, s[36:39], s6 offen lds
    v_mfma_f32_16x16x32_bf16 v[16:19], v[52:55], v[120:123], v[16:19]
    ds_read_b128 v[76:79], v2 offset:41984
    v_mfma_f32_16x16x32_bf16 v[20:23], v[56:59], v[116:119], v[20:23]
    s_add_u32 m0, s57, 30720
    s_add_u32 s6, s49, 26624
    buffer_load_dwordx4 v1, s[36:39], s6 offen lds
    v_mfma_f32_16x16x32_bf16 v[24:27], v[56:59], v[120:123], v[24:27]
    ds_read_b128 v[80:83], v2 offset:43008
    v_mfma_f32_16x16x32_bf16 v[28:31], v[60:63], v[116:119], v[28:31]
    s_add_u32 m0, s58, 30720
    s_add_u32 s6, s50, 26624
    s_mov_b64 exec, 0xffffffff
    buffer_load_dwordx4 v1, s[36:39], s6 offen lds
    s_mov_b64 exec, -1
    v_mfma_f32_16x16x32_bf16 v[32:35], v[60:63], v[120:123], v[32:35]
    ds_read_b128 v[84:87], v2 offset:44032
    s_add_u32 s7, s54, 24576
    buffer_load_dwordx4 v[108:111], v1, s[36:39], s7 offen
    v_mfma_f32_16x16x32_bf16 v[36:39], v[64:67], v[116:119], v[36:39]
    ds_read_b128 v[88:91], v2 offset:45056
    v_mfma_f32_16x16x32_bf16 v[40:43], v[64:67], v[120:123], v[40:43]
    s_add_u32 s7, s54, 79872
    buffer_load_dwordx4 v[112:115], v1, s[36:39], s7 offen
    v_mfma_f32_16x16x32_bf16 v[44:47], v[68:71], v[116:119], v[44:47]
    global_load_dwordx2 v[136:137], v8, s[8:9] offset:64
    v_mfma_f32_16x16x32_bf16 v[48:51], v[68:71], v[120:123], v[48:51]
    global_load_dwordx2 v[156:157], v9, s[20:21] offset:64
    s_waitcnt lgkmcnt(0)
    s_waitcnt vmcnt(23)
    s_barrier
    v_mfma_f32_16x16x32_bf16 v[12:15], v[72:75], v[124:127], v[12:15]
    ds_read_b128 v[52:55], v2 offset:0
    s_add_u32 m0, s56, 40960
    s_add_u32 s6, s48, 28672
    buffer_load_dwordx4 v1, s[36:39], s6 offen lds
    v_mfma_f32_16x16x32_bf16 v[16:19], v[72:75], v[128:131], v[16:19]
    ds_read_b128 v[56:59], v2 offset:1024
    v_mfma_f32_16x16x32_bf16 v[20:23], v[76:79], v[124:127], v[20:23]
    s_add_u32 m0, s57, 40960
    s_add_u32 s6, s49, 28672
    buffer_load_dwordx4 v1, s[36:39], s6 offen lds
    v_mfma_f32_16x16x32_bf16 v[24:27], v[76:79], v[128:131], v[24:27]
    ds_read_b128 v[60:63], v2 offset:2048
    v_mfma_f32_16x16x32_bf16 v[28:31], v[80:83], v[124:127], v[28:31]
    s_add_u32 m0, s58, 40960
    s_add_u32 s6, s50, 28672
    s_mov_b64 exec, 0xffffffff
    buffer_load_dwordx4 v1, s[36:39], s6 offen lds
    s_mov_b64 exec, -1
    v_mfma_f32_16x16x32_bf16 v[32:35], v[80:83], v[128:131], v[32:35]
    ds_read_b128 v[64:67], v2 offset:3072
    s_add_u32 s7, s54, 26624
    buffer_load_dwordx4 v[116:119], v1, s[36:39], s7 offen
    v_mfma_f32_16x16x32_bf16 v[36:39], v[84:87], v[124:127], v[36:39]
    ds_read_b128 v[68:71], v2 offset:4096
    v_mfma_f32_16x16x32_bf16 v[40:43], v[84:87], v[128:131], v[40:43]
    s_add_u32 s7, s54, 81920
    buffer_load_dwordx4 v[120:123], v1, s[36:39], s7 offen
    v_mfma_f32_16x16x32_bf16 v[44:47], v[88:91], v[124:127], v[44:47]
    buffer_load_dwordx2 v[146:147], v10, s[36:39], s40 offen offset:1024
    v_mfma_f32_16x16x32_bf16 v[48:51], v[88:91], v[128:131], v[48:51]
    s_add_u32 s42, s41, 131072
    buffer_load_ushort v172, v11, s[36:39], s42 offen
    s_waitcnt lgkmcnt(0)
    s_waitcnt vmcnt(23)
    s_barrier
    v_mfma_f32_16x16x32_bf16 v[12:15], v[52:55], v[92:95], v[12:15]
    ds_read_b128 v[72:75], v2 offset:10240
    s_add_u32 m0, s56, 0
    s_add_u32 s6, s48, 30720
    buffer_load_dwordx4 v1, s[36:39], s6 offen lds
    v_mfma_f32_16x16x32_bf16 v[16:19], v[52:55], v[96:99], v[16:19]
    ds_read_b128 v[76:79], v2 offset:11264
    v_mfma_f32_16x16x32_bf16 v[20:23], v[56:59], v[92:95], v[20:23]
    s_add_u32 m0, s57, 0
    s_add_u32 s6, s49, 30720
    buffer_load_dwordx4 v1, s[36:39], s6 offen lds
    v_mfma_f32_16x16x32_bf16 v[24:27], v[56:59], v[96:99], v[24:27]
    ds_read_b128 v[80:83], v2 offset:12288
    v_mfma_f32_16x16x32_bf16 v[28:31], v[60:63], v[92:95], v[28:31]
    s_add_u32 m0, s58, 0
    s_add_u32 s6, s50, 30720
    s_mov_b64 exec, 0xffffffff
    buffer_load_dwordx4 v1, s[36:39], s6 offen lds
    s_mov_b64 exec, -1
    v_mfma_f32_16x16x32_bf16 v[32:35], v[60:63], v[96:99], v[32:35]
    ds_read_b128 v[84:87], v2 offset:13312
    s_add_u32 s7, s54, 28672
    buffer_load_dwordx4 v[124:127], v1, s[36:39], s7 offen
    v_mfma_f32_16x16x32_bf16 v[36:39], v[64:67], v[92:95], v[36:39]
    ds_read_b128 v[88:91], v2 offset:14336
    v_mfma_f32_16x16x32_bf16 v[40:43], v[64:67], v[96:99], v[40:43]
    s_add_u32 s7, s54, 83968
    buffer_load_dwordx4 v[128:131], v1, s[36:39], s7 offen
    v_mfma_f32_16x16x32_bf16 v[44:47], v[68:71], v[92:95], v[44:47]
    s_add_u32 s42, s41, 135168
    buffer_load_ushort v173, v11, s[36:39], s42 offen
    v_mfma_f32_16x16x32_bf16 v[48:51], v[68:71], v[96:99], v[48:51]
    s_add_u32 s42, s41, 139264
    buffer_load_ushort v174, v11, s[36:39], s42 offen
    s_waitcnt lgkmcnt(0)
    s_waitcnt vmcnt(23)
    s_barrier
    v_mfma_f32_16x16x32_bf16 v[12:15], v[72:75], v[100:103], v[12:15]
    ds_read_b128 v[52:55], v2 offset:20480
    s_add_u32 m0, s56, 10240
    s_add_u32 s6, s48, 32768
    buffer_load_dwordx4 v1, s[36:39], s6 offen lds
    v_mfma_f32_16x16x32_bf16 v[16:19], v[72:75], v[104:107], v[16:19]
    ds_read_b128 v[56:59], v2 offset:21504
    v_mfma_f32_16x16x32_bf16 v[20:23], v[76:79], v[100:103], v[20:23]
    s_add_u32 m0, s57, 10240
    s_add_u32 s6, s49, 32768
    buffer_load_dwordx4 v1, s[36:39], s6 offen lds
    v_mfma_f32_16x16x32_bf16 v[24:27], v[76:79], v[104:107], v[24:27]
    ds_read_b128 v[60:63], v2 offset:22528
    v_mfma_f32_16x16x32_bf16 v[28:31], v[80:83], v[100:103], v[28:31]
    s_add_u32 m0, s58, 10240
    s_add_u32 s6, s50, 32768
    s_mov_b64 exec, 0xffffffff
    buffer_load_dwordx4 v1, s[36:39], s6 offen lds
    s_mov_b64 exec, -1
    v_mfma_f32_16x16x32_bf16 v[32:35], v[80:83], v[104:107], v[32:35]
    ds_read_b128 v[64:67], v2 offset:23552
    s_add_u32 s7, s54, 30720
    buffer_load_dwordx4 v[92:95], v1, s[36:39], s7 offen
    v_mfma_f32_16x16x32_bf16 v[36:39], v[84:87], v[100:103], v[36:39]
    ds_read_b128 v[68:71], v2 offset:24576
    v_mfma_f32_16x16x32_bf16 v[40:43], v[84:87], v[104:107], v[40:43]
    s_add_u32 s7, s54, 86016
    buffer_load_dwordx4 v[96:99], v1, s[36:39], s7 offen
    v_mfma_f32_16x16x32_bf16 v[44:47], v[88:91], v[100:103], v[44:47]
    s_add_u32 s42, s41, 143360
    buffer_load_ushort v175, v11, s[36:39], s42 offen
    v_mfma_f32_16x16x32_bf16 v[48:51], v[88:91], v[104:107], v[48:51]
    global_load_dwordx2 v[138:139], v8, s[8:9] offset:96
    s_waitcnt lgkmcnt(0)
    s_waitcnt vmcnt(23)
    s_barrier
    v_mfma_f32_16x16x32_bf16 v[12:15], v[52:55], v[108:111], v[12:15]
    ds_read_b128 v[72:75], v2 offset:30720
    s_add_u32 m0, s56, 20480
    s_add_u32 s6, s48, 34816
    buffer_load_dwordx4 v1, s[36:39], s6 offen lds
    v_mfma_f32_16x16x32_bf16 v[16:19], v[52:55], v[112:115], v[16:19]
    ds_read_b128 v[76:79], v2 offset:31744
    v_mfma_f32_16x16x32_bf16 v[20:23], v[56:59], v[108:111], v[20:23]
    s_add_u32 m0, s57, 20480
    s_add_u32 s6, s49, 34816
    buffer_load_dwordx4 v1, s[36:39], s6 offen lds
    v_mfma_f32_16x16x32_bf16 v[24:27], v[56:59], v[112:115], v[24:27]
    ds_read_b128 v[80:83], v2 offset:32768
    v_mfma_f32_16x16x32_bf16 v[28:31], v[60:63], v[108:111], v[28:31]
    s_add_u32 m0, s58, 20480
    s_add_u32 s6, s50, 34816
    s_mov_b64 exec, 0xffffffff
    buffer_load_dwordx4 v1, s[36:39], s6 offen lds
    s_mov_b64 exec, -1
    v_mfma_f32_16x16x32_bf16 v[32:35], v[60:63], v[112:115], v[32:35]
    ds_read_b128 v[84:87], v2 offset:33792
    s_add_u32 s7, s54, 32768
    buffer_load_dwordx4 v[100:103], v1, s[36:39], s7 offen
    v_mfma_f32_16x16x32_bf16 v[36:39], v[64:67], v[108:111], v[36:39]
    ds_read_b128 v[88:91], v2 offset:34816
    v_mfma_f32_16x16x32_bf16 v[40:43], v[64:67], v[112:115], v[40:43]
    s_add_u32 s7, s54, 88064
    buffer_load_dwordx4 v[104:107], v1, s[36:39], s7 offen
    v_mfma_f32_16x16x32_bf16 v[44:47], v[68:71], v[108:111], v[44:47]
    global_load_dwordx2 v[158:159], v9, s[20:21] offset:96
    v_mfma_f32_16x16x32_bf16 v[48:51], v[68:71], v[112:115], v[48:51]
    buffer_load_dwordx2 v[148:149], v10, s[36:39], s40 offen offset:1536
    s_waitcnt lgkmcnt(0)
    s_waitcnt vmcnt(23)
    s_barrier
    v_mfma_f32_16x16x32_bf16 v[12:15], v[72:75], v[116:119], v[12:15]
    ds_read_b128 v[52:55], v2 offset:40960
    s_add_u32 m0, s56, 30720
    s_add_u32 s6, s48, 36864
    buffer_load_dwordx4 v1, s[36:39], s6 offen lds
    v_mfma_f32_16x16x32_bf16 v[16:19], v[72:75], v[120:123], v[16:19]
    ds_read_b128 v[56:59], v2 offset:41984
    v_mfma_f32_16x16x32_bf16 v[20:23], v[76:79], v[116:119], v[20:23]
    s_add_u32 m0, s57, 30720
    s_add_u32 s6, s49, 36864
    buffer_load_dwordx4 v1, s[36:39], s6 offen lds
    v_mfma_f32_16x16x32_bf16 v[24:27], v[76:79], v[120:123], v[24:27]
    ds_read_b128 v[60:63], v2 offset:43008
    v_mfma_f32_16x16x32_bf16 v[28:31], v[80:83], v[116:119], v[28:31]
    s_add_u32 m0, s58, 30720
    s_add_u32 s6, s50, 36864
    s_mov_b64 exec, 0xffffffff
    buffer_load_dwordx4 v1, s[36:39], s6 offen lds
    s_mov_b64 exec, -1
    v_mfma_f32_16x16x32_bf16 v[32:35], v[80:83], v[120:123], v[32:35]
    ds_read_b128 v[64:67], v2 offset:44032
    s_add_u32 s7, s54, 34816
    buffer_load_dwordx4 v[108:111], v1, s[36:39], s7 offen
    v_mfma_f32_16x16x32_bf16 v[36:39], v[84:87], v[116:119], v[36:39]
    ds_read_b128 v[68:71], v2 offset:45056
    v_mfma_f32_16x16x32_bf16 v[40:43], v[84:87], v[120:123], v[40:43]
    s_add_u32 s7, s54, 90112
    buffer_load_dwordx4 v[112:115], v1, s[36:39], s7 offen
    v_mfma_f32_16x16x32_bf16 v[44:47], v[88:91], v[116:119], v[44:47]
    s_add_u32 s42, s41, 196608
    buffer_load_ushort v176, v11, s[36:39], s42 offen
    v_mfma_f32_16x16x32_bf16 v[48:51], v[88:91], v[120:123], v[48:51]
    s_add_u32 s42, s41, 200704
    buffer_load_ushort v177, v11, s[36:39], s42 offen
    s_waitcnt lgkmcnt(0)
    s_waitcnt vmcnt(23)
    s_barrier
    v_mfma_f32_16x16x32_bf16 v[12:15], v[52:55], v[124:127], v[12:15]
    ds_read_b128 v[72:75], v2 offset:0
    s_add_u32 m0, s56, 40960
    s_add_u32 s6, s48, 38912
    buffer_load_dwordx4 v1, s[36:39], s6 offen lds
    v_mfma_f32_16x16x32_bf16 v[16:19], v[52:55], v[128:131], v[16:19]
    ds_read_b128 v[76:79], v2 offset:1024
    v_mfma_f32_16x16x32_bf16 v[20:23], v[56:59], v[124:127], v[20:23]
    s_add_u32 m0, s57, 40960
    s_add_u32 s6, s49, 38912
    buffer_load_dwordx4 v1, s[36:39], s6 offen lds
    v_mfma_f32_16x16x32_bf16 v[24:27], v[56:59], v[128:131], v[24:27]
    ds_read_b128 v[80:83], v2 offset:2048
    v_mfma_f32_16x16x32_bf16 v[28:31], v[60:63], v[124:127], v[28:31]
    s_add_u32 m0, s58, 40960
    s_add_u32 s6, s50, 38912
    s_mov_b64 exec, 0xffffffff
    buffer_load_dwordx4 v1, s[36:39], s6 offen lds
    s_mov_b64 exec, -1
    v_mfma_f32_16x16x32_bf16 v[32:35], v[60:63], v[128:131], v[32:35]
    ds_read_b128 v[84:87], v2 offset:3072
    s_add_u32 s7, s54, 36864
    buffer_load_dwordx4 v[116:119], v1, s[36:39], s7 offen
    v_mfma_f32_16x16x32_bf16 v[36:39], v[64:67], v[124:127], v[36:39]
    ds_read_b128 v[88:91], v2 offset:4096
    v_mfma_f32_16x16x32_bf16 v[40:43], v[64:67], v[128:131], v[40:43]
    s_add_u32 s7, s54, 92160
    buffer_load_dwordx4 v[120:123], v1, s[36:39], s7 offen
    v_mfma_f32_16x16x32_bf16 v[44:47], v[68:71], v[124:127], v[44:47]
    s_add_u32 s42, s41, 204800
    buffer_load_ushort v178, v11, s[36:39], s42 offen
    v_mfma_f32_16x16x32_bf16 v[48:51], v[68:71], v[128:131], v[48:51]
    s_add_u32 s42, s41, 208896
    buffer_load_ushort v179, v11, s[36:39], s42 offen
    s_waitcnt lgkmcnt(0)
    s_waitcnt vmcnt(23)
    s_barrier
    v_mfma_f32_16x16x32_bf16 v[12:15], v[72:75], v[92:95], v[12:15]
    ds_read_b128 v[52:55], v2 offset:10240
    s_add_u32 m0, s56, 0
    s_add_u32 s6, s48, 40960
    buffer_load_dwordx4 v1, s[36:39], s6 offen lds
    v_mfma_f32_16x16x32_bf16 v[16:19], v[72:75], v[96:99], v[16:19]
    ds_read_b128 v[56:59], v2 offset:11264
    v_mfma_f32_16x16x32_bf16 v[20:23], v[76:79], v[92:95], v[20:23]
    s_add_u32 m0, s57, 0
    s_add_u32 s6, s49, 40960
    buffer_load_dwordx4 v1, s[36:39], s6 offen lds
    v_mfma_f32_16x16x32_bf16 v[24:27], v[76:79], v[96:99], v[24:27]
    ds_read_b128 v[60:63], v2 offset:12288
    v_mfma_f32_16x16x32_bf16 v[28:31], v[80:83], v[92:95], v[28:31]
    s_add_u32 m0, s58, 0
    s_add_u32 s6, s50, 40960
    s_mov_b64 exec, 0xffffffff
    buffer_load_dwordx4 v1, s[36:39], s6 offen lds
    s_mov_b64 exec, -1
    v_mfma_f32_16x16x32_bf16 v[32:35], v[80:83], v[96:99], v[32:35]
    ds_read_b128 v[64:67], v2 offset:13312
    s_add_u32 s7, s54, 38912
    buffer_load_dwordx4 v[124:127], v1, s[36:39], s7 offen
    v_mfma_f32_16x16x32_bf16 v[36:39], v[84:87], v[92:95], v[36:39]
    ds_read_b128 v[68:71], v2 offset:14336
    v_mfma_f32_16x16x32_bf16 v[40:43], v[84:87], v[96:99], v[40:43]
    s_add_u32 s7, s54, 94208
    buffer_load_dwordx4 v[128:131], v1, s[36:39], s7 offen
    v_mfma_f32_16x16x32_bf16 v[44:47], v[88:91], v[92:95], v[44:47]
    global_load_dwordx2 v[140:141], v8, s[8:9] offset:128
    v_mfma_f32_16x16x32_bf16 v[48:51], v[88:91], v[96:99], v[48:51]
    global_load_dwordx2 v[160:161], v9, s[20:21] offset:128
    s_waitcnt lgkmcnt(0)
    s_waitcnt vmcnt(23)
    s_barrier
    v_mfma_f32_16x16x32_bf16 v[12:15], v[52:55], v[100:103], v[12:15]
    ds_read_b128 v[72:75], v2 offset:20480
    s_add_u32 m0, s56, 10240
    s_add_u32 s6, s48, 43008
    buffer_load_dwordx4 v1, s[36:39], s6 offen lds
    v_mfma_f32_16x16x32_bf16 v[16:19], v[52:55], v[104:107], v[16:19]
    ds_read_b128 v[76:79], v2 offset:21504
    v_mfma_f32_16x16x32_bf16 v[20:23], v[56:59], v[100:103], v[20:23]
    s_add_u32 m0, s57, 10240
    s_add_u32 s6, s49, 43008
    buffer_load_dwordx4 v1, s[36:39], s6 offen lds
    v_mfma_f32_16x16x32_bf16 v[24:27], v[56:59], v[104:107], v[24:27]
    ds_read_b128 v[80:83], v2 offset:22528
    v_mfma_f32_16x16x32_bf16 v[28:31], v[60:63], v[100:103], v[28:31]
    s_add_u32 m0, s58, 10240
    s_add_u32 s6, s50, 43008
    s_mov_b64 exec, 0xffffffff
    buffer_load_dwordx4 v1, s[36:39], s6 offen lds
    s_mov_b64 exec, -1
    v_mfma_f32_16x16x32_bf16 v[32:35], v[60:63], v[104:107], v[32:35]
    ds_read_b128 v[84:87], v2 offset:23552
    s_add_u32 s7, s54, 40960
    buffer_load_dwordx4 v[92:95], v1, s[36:39], s7 offen
    v_mfma_f32_16x16x32_bf16 v[36:39], v[64:67], v[100:103], v[36:39]
    ds_read_b128 v[88:91], v2 offset:24576
    v_mfma_f32_16x16x32_bf16 v[40:43], v[64:67], v[104:107], v[40:43]
    s_add_u32 s7, s54, 96256
    buffer_load_dwordx4 v[96:99], v1, s[36:39], s7 offen
    v_mfma_f32_16x16x32_bf16 v[44:47], v[68:71], v[100:103], v[44:47]
    buffer_load_dwordx2 v[150:151], v10, s[36:39], s40 offen offset:2048
    v_mfma_f32_16x16x32_bf16 v[48:51], v[68:71], v[104:107], v[48:51]
    s_add_u32 s42, s41, 262144
    buffer_load_ushort v180, v11, s[36:39], s42 offen
    s_waitcnt lgkmcnt(0)
    s_waitcnt vmcnt(23)
    s_barrier
    v_mfma_f32_16x16x32_bf16 v[12:15], v[72:75], v[108:111], v[12:15]
    ds_read_b128 v[52:55], v2 offset:30720
    s_add_u32 m0, s56, 20480
    s_add_u32 s6, s48, 45056
    buffer_load_dwordx4 v1, s[36:39], s6 offen lds
    v_mfma_f32_16x16x32_bf16 v[16:19], v[72:75], v[112:115], v[16:19]
    ds_read_b128 v[56:59], v2 offset:31744
    v_mfma_f32_16x16x32_bf16 v[20:23], v[76:79], v[108:111], v[20:23]
    s_add_u32 m0, s57, 20480
    s_add_u32 s6, s49, 45056
    buffer_load_dwordx4 v1, s[36:39], s6 offen lds
    v_mfma_f32_16x16x32_bf16 v[24:27], v[76:79], v[112:115], v[24:27]
    ds_read_b128 v[60:63], v2 offset:32768
    v_mfma_f32_16x16x32_bf16 v[28:31], v[80:83], v[108:111], v[28:31]
    s_add_u32 m0, s58, 20480
    s_add_u32 s6, s50, 45056
    s_mov_b64 exec, 0xffffffff
    buffer_load_dwordx4 v1, s[36:39], s6 offen lds
    s_mov_b64 exec, -1
    v_mfma_f32_16x16x32_bf16 v[32:35], v[80:83], v[112:115], v[32:35]
    ds_read_b128 v[64:67], v2 offset:33792
    s_add_u32 s7, s54, 43008
    buffer_load_dwordx4 v[100:103], v1, s[36:39], s7 offen
    v_mfma_f32_16x16x32_bf16 v[36:39], v[84:87], v[108:111], v[36:39]
    ds_read_b128 v[68:71], v2 offset:34816
    v_mfma_f32_16x16x32_bf16 v[40:43], v[84:87], v[112:115], v[40:43]
    s_add_u32 s7, s54, 98304
    buffer_load_dwordx4 v[104:107], v1, s[36:39], s7 offen
    v_mfma_f32_16x16x32_bf16 v[44:47], v[88:91], v[108:111], v[44:47]
    s_add_u32 s42, s41, 266240
    buffer_load_ushort v181, v11, s[36:39], s42 offen
    v_mfma_f32_16x16x32_bf16 v[48:51], v[88:91], v[112:115], v[48:51]
    s_add_u32 s42, s41, 270336
    buffer_load_ushort v182, v11, s[36:39], s42 offen
    s_waitcnt lgkmcnt(0)
    s_waitcnt vmcnt(23)
    s_barrier
    v_mfma_f32_16x16x32_bf16 v[12:15], v[52:55], v[116:119], v[12:15]
    ds_read_b128 v[72:75], v2 offset:40960
    s_add_u32 m0, s56, 30720
    s_add_u32 s6, s48, 47104
    buffer_load_dwordx4 v1, s[36:39], s6 offen lds
    v_mfma_f32_16x16x32_bf16 v[16:19], v[52:55], v[120:123], v[16:19]
    ds_read_b128 v[76:79], v2 offset:41984
    v_mfma_f32_16x16x32_bf16 v[20:23], v[56:59], v[116:119], v[20:23]
    s_add_u32 m0, s57, 30720
    s_add_u32 s6, s49, 47104
    buffer_load_dwordx4 v1, s[36:39], s6 offen lds
    v_mfma_f32_16x16x32_bf16 v[24:27], v[56:59], v[120:123], v[24:27]
    ds_read_b128 v[80:83], v2 offset:43008
    v_mfma_f32_16x16x32_bf16 v[28:31], v[60:63], v[116:119], v[28:31]
    s_add_u32 m0, s58, 30720
    s_add_u32 s6, s50, 47104
    s_mov_b64 exec, 0xffffffff
    buffer_load_dwordx4 v1, s[36:39], s6 offen lds
    s_mov_b64 exec, -1
    v_mfma_f32_16x16x32_bf16 v[32:35], v[60:63], v[120:123], v[32:35]
    ds_read_b128 v[84:87], v2 offset:44032
    v_mfma_f32_16x16x32_bf16 v[36:39], v[64:67], v[116:119], v[36:39]
    s_add_u32 s7, s54, 45056
    buffer_load_dwordx4 v[108:111], v1, s[36:39], s7 offen
    v_mfma_f32_16x16x32_bf16 v[40:43], v[64:67], v[120:123], v[40:43]
    ds_read_b128 v[88:91], v2 offset:45056
    v_mfma_f32_16x16x32_bf16 v[44:47], v[68:71], v[116:119], v[44:47]
    s_add_u32 s7, s54, 100352
    buffer_load_dwordx4 v[112:115], v1, s[36:39], s7 offen
    v_mfma_f32_16x16x32_bf16 v[48:51], v[68:71], v[120:123], v[48:51]
    s_add_u32 s42, s41, 274432
    buffer_load_ushort v183, v11, s[36:39], s42 offen
    s_waitcnt lgkmcnt(0)
    s_waitcnt vmcnt(22)
    s_barrier
    v_mfma_f32_16x16x32_bf16 v[12:15], v[72:75], v[124:127], v[12:15]
    ds_read_b128 v[52:55], v2 offset:0
    v_mfma_f32_16x16x32_bf16 v[16:19], v[72:75], v[128:131], v[16:19]
    s_add_u32 m0, s56, 40960
    s_add_u32 s6, s48, 49152
    buffer_load_dwordx4 v1, s[36:39], s6 offen lds
    v_mfma_f32_16x16x32_bf16 v[20:23], v[76:79], v[124:127], v[20:23]
    ds_read_b128 v[56:59], v2 offset:1024
    v_mfma_f32_16x16x32_bf16 v[24:27], v[76:79], v[128:131], v[24:27]
    s_add_u32 m0, s57, 40960
    s_add_u32 s6, s49, 49152
    buffer_load_dwordx4 v1, s[36:39], s6 offen lds
    v_mfma_f32_16x16x32_bf16 v[28:31], v[80:83], v[124:127], v[28:31]
    ds_read_b128 v[60:63], v2 offset:2048
    v_mfma_f32_16x16x32_bf16 v[32:35], v[80:83], v[128:131], v[32:35]
    s_add_u32 m0, s58, 40960
    s_add_u32 s6, s50, 49152
    s_mov_b64 exec, 0xffffffff
    buffer_load_dwordx4 v1, s[36:39], s6 offen lds
    s_mov_b64 exec, -1
    v_mfma_f32_16x16x32_bf16 v[36:39], v[84:87], v[124:127], v[36:39]
    ds_read_b128 v[64:67], v2 offset:3072
    v_mfma_f32_16x16x32_bf16 v[40:43], v[84:87], v[128:131], v[40:43]
    s_add_u32 s7, s54, 47104
    buffer_load_dwordx4 v[116:119], v1, s[36:39], s7 offen
    v_mfma_f32_16x16x32_bf16 v[44:47], v[88:91], v[124:127], v[44:47]
    ds_read_b128 v[68:71], v2 offset:4096
    v_mfma_f32_16x16x32_bf16 v[48:51], v[88:91], v[128:131], v[48:51]
    s_add_u32 s7, s54, 102400
    buffer_load_dwordx4 v[120:123], v1, s[36:39], s7 offen
    s_waitcnt lgkmcnt(0)
    s_waitcnt vmcnt(20)
    s_barrier
    v_mfma_f32_16x16x32_bf16 v[12:15], v[52:55], v[92:95], v[12:15]
    ds_read_b128 v[72:75], v2 offset:10240
    v_mfma_f32_16x16x32_bf16 v[16:19], v[52:55], v[96:99], v[16:19]
    s_add_u32 m0, s56, 0
    s_add_u32 s6, s48, 51200
    buffer_load_dwordx4 v1, s[36:39], s6 offen lds
    v_mfma_f32_16x16x32_bf16 v[20:23], v[56:59], v[92:95], v[20:23]
    ds_read_b128 v[76:79], v2 offset:11264
    v_mfma_f32_16x16x32_bf16 v[24:27], v[56:59], v[96:99], v[24:27]
    s_add_u32 m0, s57, 0
    s_add_u32 s6, s49, 51200
    buffer_load_dwordx4 v1, s[36:39], s6 offen lds
    v_mfma_f32_16x16x32_bf16 v[28:31], v[60:63], v[92:95], v[28:31]
    ds_read_b128 v[80:83], v2 offset:12288
    v_mfma_f32_16x16x32_bf16 v[32:35], v[60:63], v[96:99], v[32:35]
    s_add_u32 m0, s58, 0
    s_add_u32 s6, s50, 51200
    s_mov_b64 exec, 0xffffffff
    buffer_load_dwordx4 v1, s[36:39], s6 offen lds
    s_mov_b64 exec, -1
    v_mfma_f32_16x16x32_bf16 v[36:39], v[64:67], v[92:95], v[36:39]
    ds_read_b128 v[84:87], v2 offset:13312
    v_mfma_f32_16x16x32_bf16 v[40:43], v[64:67], v[96:99], v[40:43]
    s_add_u32 s7, s54, 49152
    buffer_load_dwordx4 v[124:127], v1, s[36:39], s7 offen
    v_mfma_f32_16x16x32_bf16 v[44:47], v[68:71], v[92:95], v[44:47]
    ds_read_b128 v[88:91], v2 offset:14336
    v_mfma_f32_16x16x32_bf16 v[48:51], v[68:71], v[96:99], v[48:51]
    s_add_u32 s7, s54, 104448
    buffer_load_dwordx4 v[128:131], v1, s[36:39], s7 offen
    s_waitcnt lgkmcnt(0)
    s_waitcnt vmcnt(18)
    s_barrier
    v_mfma_f32_16x16x32_bf16 v[12:15], v[72:75], v[100:103], v[12:15]
    ds_read_b128 v[52:55], v2 offset:20480
    v_mfma_f32_16x16x32_bf16 v[16:19], v[72:75], v[104:107], v[16:19]
    s_add_u32 m0, s56, 10240
    s_add_u32 s6, s48, 53248
    buffer_load_dwordx4 v1, s[36:39], s6 offen lds
    v_mfma_f32_16x16x32_bf16 v[20:23], v[76:79], v[100:103], v[20:23]
    ds_read_b128 v[56:59], v2 offset:21504
    v_mfma_f32_16x16x32_bf16 v[24:27], v[76:79], v[104:107], v[24:27]
    s_add_u32 m0, s57, 10240
    s_add_u32 s6, s49, 53248
    buffer_load_dwordx4 v1, s[36:39], s6 offen lds
    v_mfma_f32_16x16x32_bf16 v[28:31], v[80:83], v[100:103], v[28:31]
    ds_read_b128 v[60:63], v2 offset:22528
    v_mfma_f32_16x16x32_bf16 v[32:35], v[80:83], v[104:107], v[32:35]
    s_add_u32 m0, s58, 10240
    s_add_u32 s6, s50, 53248
    s_mov_b64 exec, 0xffffffff
    buffer_load_dwordx4 v1, s[36:39], s6 offen lds
    s_mov_b64 exec, -1
    v_mfma_f32_16x16x32_bf16 v[36:39], v[84:87], v[100:103], v[36:39]
    ds_read_b128 v[64:67], v2 offset:23552
    v_mfma_f32_16x16x32_bf16 v[40:43], v[84:87], v[104:107], v[40:43]
    s_add_u32 s7, s54, 51200
    buffer_load_dwordx4 v[92:95], v1, s[36:39], s7 offen
    v_mfma_f32_16x16x32_bf16 v[44:47], v[88:91], v[100:103], v[44:47]
    ds_read_b128 v[68:71], v2 offset:24576
    v_mfma_f32_16x16x32_bf16 v[48:51], v[88:91], v[104:107], v[48:51]
    s_add_u32 s7, s54, 106496
    buffer_load_dwordx4 v[96:99], v1, s[36:39], s7 offen
    s_waitcnt lgkmcnt(0)
    s_waitcnt vmcnt(16)
    s_barrier
    v_mfma_f32_16x16x32_bf16 v[12:15], v[52:55], v[108:111], v[12:15]
    ds_read_b128 v[72:75], v2 offset:30720
    v_mfma_f32_16x16x32_bf16 v[16:19], v[52:55], v[112:115], v[16:19]
    ds_read_b128 v[76:79], v2 offset:31744
    v_mfma_f32_16x16x32_bf16 v[20:23], v[56:59], v[108:111], v[20:23]
    s_add_u32 s7, s54, 53248
    buffer_load_dwordx4 v[100:103], v1, s[36:39], s7 offen
    v_mfma_f32_16x16x32_bf16 v[24:27], v[56:59], v[112:115], v[24:27]
    v_mfma_f32_16x16x32_bf16 v[28:31], v[60:63], v[108:111], v[28:31]
    ds_read_b128 v[80:83], v2 offset:32768
    v_mfma_f32_16x16x32_bf16 v[32:35], v[60:63], v[112:115], v[32:35]
    ds_read_b128 v[84:87], v2 offset:33792
    v_mfma_f32_16x16x32_bf16 v[36:39], v[64:67], v[108:111], v[36:39]
    v_mfma_f32_16x16x32_bf16 v[40:43], v[64:67], v[112:115], v[40:43]
    s_add_u32 s7, s54, 108544
    buffer_load_dwordx4 v[104:107], v1, s[36:39], s7 offen
    v_mfma_f32_16x16x32_bf16 v[44:47], v[68:71], v[108:111], v[44:47]
    ds_read_b128 v[88:91], v2 offset:34816
    v_mfma_f32_16x16x32_bf16 v[48:51], v[68:71], v[112:115], v[48:51]
    s_waitcnt lgkmcnt(0)
    s_waitcnt vmcnt(12)
    s_barrier
    v_mfma_f32_16x16x32_bf16 v[12:15], v[72:75], v[116:119], v[12:15]
    ds_read_b128 v[52:55], v2 offset:40960
    v_mfma_f32_16x16x32_bf16 v[16:19], v[72:75], v[120:123], v[16:19]
    v_mfma_f32_16x16x32_bf16 v[20:23], v[76:79], v[116:119], v[20:23]
    ds_read_b128 v[56:59], v2 offset:41984
    v_mfma_f32_16x16x32_bf16 v[24:27], v[76:79], v[120:123], v[24:27]
    v_mfma_f32_16x16x32_bf16 v[28:31], v[80:83], v[116:119], v[28:31]
    ds_read_b128 v[60:63], v2 offset:43008
    v_mfma_f32_16x16x32_bf16 v[32:35], v[80:83], v[120:123], v[32:35]
    v_mfma_f32_16x16x32_bf16 v[36:39], v[84:87], v[116:119], v[36:39]
    ds_read_b128 v[64:67], v2 offset:44032
    v_mfma_f32_16x16x32_bf16 v[40:43], v[84:87], v[120:123], v[40:43]
    v_mfma_f32_16x16x32_bf16 v[44:47], v[88:91], v[116:119], v[44:47]
    ds_read_b128 v[68:71], v2 offset:45056
    v_mfma_f32_16x16x32_bf16 v[48:51], v[88:91], v[120:123], v[48:51]
    s_waitcnt lgkmcnt(0)
    s_waitcnt vmcnt(7)
    s_barrier
    v_mfma_f32_16x16x32_bf16 v[12:15], v[52:55], v[124:127], v[12:15]
    ds_read_b128 v[72:75], v2 offset:0
    v_mfma_f32_16x16x32_bf16 v[16:19], v[52:55], v[128:131], v[16:19]
    v_mfma_f32_16x16x32_bf16 v[20:23], v[56:59], v[124:127], v[20:23]
    ds_read_b128 v[76:79], v2 offset:1024
    v_mfma_f32_16x16x32_bf16 v[24:27], v[56:59], v[128:131], v[24:27]
    v_mfma_f32_16x16x32_bf16 v[28:31], v[60:63], v[124:127], v[28:31]
    ds_read_b128 v[80:83], v2 offset:2048
    v_mfma_f32_16x16x32_bf16 v[32:35], v[60:63], v[128:131], v[32:35]
    v_mfma_f32_16x16x32_bf16 v[36:39], v[64:67], v[124:127], v[36:39]
    ds_read_b128 v[84:87], v2 offset:3072
    v_mfma_f32_16x16x32_bf16 v[40:43], v[64:67], v[128:131], v[40:43]
    v_mfma_f32_16x16x32_bf16 v[44:47], v[68:71], v[124:127], v[44:47]
    ds_read_b128 v[88:91], v2 offset:4096
    v_mfma_f32_16x16x32_bf16 v[48:51], v[68:71], v[128:131], v[48:51]
    s_waitcnt lgkmcnt(0)
    s_waitcnt vmcnt(2)
    s_barrier
    v_mfma_f32_16x16x32_bf16 v[12:15], v[72:75], v[92:95], v[12:15]
    ds_read_b128 v[52:55], v2 offset:10240
    v_mfma_f32_16x16x32_bf16 v[16:19], v[72:75], v[96:99], v[16:19]
    v_mfma_f32_16x16x32_bf16 v[20:23], v[76:79], v[92:95], v[20:23]
    ds_read_b128 v[56:59], v2 offset:11264
    v_mfma_f32_16x16x32_bf16 v[24:27], v[76:79], v[96:99], v[24:27]
    v_mfma_f32_16x16x32_bf16 v[28:31], v[80:83], v[92:95], v[28:31]
    ds_read_b128 v[60:63], v2 offset:12288
    v_mfma_f32_16x16x32_bf16 v[32:35], v[80:83], v[96:99], v[32:35]
    v_mfma_f32_16x16x32_bf16 v[36:39], v[84:87], v[92:95], v[36:39]
    ds_read_b128 v[64:67], v2 offset:13312
    v_mfma_f32_16x16x32_bf16 v[40:43], v[84:87], v[96:99], v[40:43]
    v_mfma_f32_16x16x32_bf16 v[44:47], v[88:91], v[92:95], v[44:47]
    ds_read_b128 v[68:71], v2 offset:14336
    v_mfma_f32_16x16x32_bf16 v[48:51], v[88:91], v[96:99], v[48:51]
    s_waitcnt lgkmcnt(0)
    s_waitcnt vmcnt(0)
    v_mfma_f32_16x16x32_bf16 v[12:15], v[52:55], v[100:103], v[12:15]
    v_mfma_f32_16x16x32_bf16 v[16:19], v[52:55], v[104:107], v[16:19]
    v_mfma_f32_16x16x32_bf16 v[20:23], v[56:59], v[100:103], v[20:23]
    v_mfma_f32_16x16x32_bf16 v[24:27], v[56:59], v[104:107], v[24:27]
    v_mfma_f32_16x16x32_bf16 v[28:31], v[60:63], v[100:103], v[28:31]
    v_mfma_f32_16x16x32_bf16 v[32:35], v[60:63], v[104:107], v[32:35]
    v_mfma_f32_16x16x32_bf16 v[36:39], v[64:67], v[100:103], v[36:39]
    v_mfma_f32_16x16x32_bf16 v[40:43], v[64:67], v[104:107], v[40:43]
    v_mfma_f32_16x16x32_bf16 v[44:47], v[68:71], v[100:103], v[44:47]
    v_mfma_f32_16x16x32_bf16 v[48:51], v[68:71], v[104:107], v[48:51]
    s_nop 7
    s_barrier
    s_mul_i32 s6, s3, 5120
    v_add_u32 v3, s6, v1
    s_xor_b32 s7, s3, 2
    s_mul_i32 s7, s7, 5120
    v_add_u32 v4, s7, v1
    s_cmp_eq_u32 s46, 0
    s_cbranch_scc1 L_x_6
    ds_write_b128 v3, v[12:15] offset:0
    ds_write_b128 v3, v[20:23] offset:1024
    ds_write_b128 v3, v[28:31] offset:2048
    ds_write_b128 v3, v[36:39] offset:3072
    ds_write_b128 v3, v[44:47] offset:4096
    s_nop 3
    v_mov_b32 v12, v16
    v_mov_b32 v13, v17
    v_mov_b32 v14, v18
    v_mov_b32 v15, v19
    v_mov_b32 v20, v24
    v_mov_b32 v21, v25
    v_mov_b32 v22, v26
    v_mov_b32 v23, v27
    v_mov_b32 v28, v32
    v_mov_b32 v29, v33
    v_mov_b32 v30, v34
    v_mov_b32 v31, v35
    v_mov_b32 v36, v40
    v_mov_b32 v37, v41
    v_mov_b32 v38, v42
    v_mov_b32 v39, v43
    v_mov_b32 v44, v48
    v_mov_b32 v45, v49
    v_mov_b32 v46, v50
    v_mov_b32 v47, v51
    s_branch L_x_7
L_x_6:
    ds_write_b128 v3, v[16:19] offset:0
    ds_write_b128 v3, v[24:27] offset:1024
    ds_write_b128 v3, v[32:35] offset:2048
    ds_write_b128 v3, v[40:43] offset:3072
    ds_write_b128 v3, v[48:51] offset:4096
L_x_7:
    s_waitcnt lgkmcnt(0)
    s_barrier
    ds_read_b128 v[16:19], v4 offset:0
    ds_read_b128 v[24:27], v4 offset:1024
    ds_read_b128 v[32:35], v4 offset:2048
    ds_read_b128 v[40:43], v4 offset:3072
    ds_read_b128 v[48:51], v4 offset:4096
    v_lshlrev_b32 v52, 16, v132
    v_and_b32 v53, 0xffff0000, v132
    v_lshlrev_b32 v54, 16, v133
    v_and_b32 v55, 0xffff0000, v133
    v_lshlrev_b32 v56, 16, v142
    v_and_b32 v57, 0xffff0000, v142
    v_lshlrev_b32 v58, 16, v143
    v_and_b32 v59, 0xffff0000, v143
    v_lshlrev_b32 v60, 16, v152
    v_and_b32 v61, 0xffff0000, v152
    v_lshlrev_b32 v62, 16, v153
    v_and_b32 v63, 0xffff0000, v153
    v_lshlrev_b32 v164, 16, v164
    v_mul_f32 v56, v56, v60
    v_lshlrev_b32 v165, 16, v165
    v_mul_f32 v57, v57, v61
    v_lshlrev_b32 v166, 16, v166
    v_mul_f32 v58, v58, v62
    v_lshlrev_b32 v167, 16, v167
    v_mul_f32 v59, v59, v63
    v_cvt_pk_bf16_f32 v64, v56, v57
    v_cvt_pk_bf16_f32 v65, v58, v59
    v_lshlrev_b32 v56, 16, v64
    v_and_b32 v57, 0xffff0000, v64
    v_lshlrev_b32 v58, 16, v65
    v_and_b32 v59, 0xffff0000, v65
    v_add_f32 v56, v56, v164
    v_add_f32 v57, v57, v165
    v_add_f32 v58, v58, v166
    v_add_f32 v59, v59, v167
    v_cvt_pk_bf16_f32 v64, v56, v57
    v_cvt_pk_bf16_f32 v65, v58, v59
    v_lshlrev_b32 v56, 16, v64
    v_and_b32 v57, 0xffff0000, v64
    v_lshlrev_b32 v58, 16, v65
    v_and_b32 v59, 0xffff0000, v65
    v_add_f32 v56, v56, v52
    v_add_f32 v57, v57, v53
    v_add_f32 v58, v58, v54
    v_add_f32 v59, v59, v55
    v_cvt_pk_bf16_f32 v64, v56, v57
    v_cvt_pk_bf16_f32 v65, v58, v59
    v_lshlrev_b32 v56, 16, v64
    v_and_b32 v57, 0xffff0000, v64
    v_lshlrev_b32 v58, 16, v65
    v_and_b32 v59, 0xffff0000, v65
    s_waitcnt lgkmcnt(4)
    v_add_f32 v12, v12, v16
    v_add_f32 v13, v13, v17
    v_add_f32 v14, v14, v18
    v_add_f32 v15, v15, v19
    v_cvt_pk_bf16_f32 v64, v12, v13
    v_cvt_pk_bf16_f32 v65, v14, v15
    v_lshlrev_b32 v12, 16, v64
    v_and_b32 v13, 0xffff0000, v64
    v_lshlrev_b32 v14, 16, v65
    v_and_b32 v15, 0xffff0000, v65
    v_add_f32 v56, v56, v12
    v_add_f32 v57, v57, v13
    v_add_f32 v58, v58, v14
    v_add_f32 v59, v59, v15
    v_cvt_pk_bf16_f32 v80, v56, v57
    v_cvt_pk_bf16_f32 v81, v58, v59
    global_store_dwordx2 v8, v[80:81], s[30:31] offset:0 sc0 sc1
    v_lshlrev_b32 v52, 16, v134
    v_and_b32 v53, 0xffff0000, v134
    v_lshlrev_b32 v54, 16, v135
    v_and_b32 v55, 0xffff0000, v135
    v_lshlrev_b32 v56, 16, v144
    v_and_b32 v57, 0xffff0000, v144
    v_lshlrev_b32 v58, 16, v145
    v_and_b32 v59, 0xffff0000, v145
    v_lshlrev_b32 v60, 16, v154
    v_and_b32 v61, 0xffff0000, v154
    v_lshlrev_b32 v62, 16, v155
    v_and_b32 v63, 0xffff0000, v155
    v_lshlrev_b32 v168, 16, v168
    v_mul_f32 v56, v56, v60
    v_lshlrev_b32 v169, 16, v169
    v_mul_f32 v57, v57, v61
    v_lshlrev_b32 v170, 16, v170
    v_mul_f32 v58, v58, v62
    v_lshlrev_b32 v171, 16, v171
    v_mul_f32 v59, v59, v63
    v_cvt_pk_bf16_f32 v64, v56, v57
    v_cvt_pk_bf16_f32 v65, v58, v59
    v_lshlrev_b32 v56, 16, v64
    v_and_b32 v57, 0xffff0000, v64
    v_lshlrev_b32 v58, 16, v65
    v_and_b32 v59, 0xffff0000, v65
    v_add_f32 v56, v56, v168
    v_add_f32 v57, v57, v169
    v_add_f32 v58, v58, v170
    v_add_f32 v59, v59, v171
    v_cvt_pk_bf16_f32 v64, v56, v57
    v_cvt_pk_bf16_f32 v65, v58, v59
    v_lshlrev_b32 v56, 16, v64
    v_and_b32 v57, 0xffff0000, v64
    v_lshlrev_b32 v58, 16, v65
    v_and_b32 v59, 0xffff0000, v65
    v_add_f32 v56, v56, v52
    v_add_f32 v57, v57, v53
    v_add_f32 v58, v58, v54
    v_add_f32 v59, v59, v55
    v_cvt_pk_bf16_f32 v64, v56, v57
    v_cvt_pk_bf16_f32 v65, v58, v59
    v_lshlrev_b32 v56, 16, v64
    v_and_b32 v57, 0xffff0000, v64
    v_lshlrev_b32 v58, 16, v65
    v_and_b32 v59, 0xffff0000, v65
    s_waitcnt lgkmcnt(3)
    v_add_f32 v20, v20, v24
    v_add_f32 v21, v21, v25
    v_add_f32 v22, v22, v26
    v_add_f32 v23, v23, v27
    v_cvt_pk_bf16_f32 v64, v20, v21
    v_cvt_pk_bf16_f32 v65, v22, v23
    v_lshlrev_b32 v20, 16, v64
    v_and_b32 v21, 0xffff0000, v64
    v_lshlrev_b32 v22, 16, v65
    v_and_b32 v23, 0xffff0000, v65
    v_add_f32 v56, v56, v20
    v_add_f32 v57, v57, v21
    v_add_f32 v58, v58, v22
    v_add_f32 v59, v59, v23
    v_cvt_pk_bf16_f32 v82, v56, v57
    v_cvt_pk_bf16_f32 v83, v58, v59
    global_store_dwordx2 v8, v[82:83], s[30:31] offset:32 sc0 sc1
    v_lshlrev_b32 v52, 16, v136
    v_and_b32 v53, 0xffff0000, v136
    v_lshlrev_b32 v54, 16, v137
    v_and_b32 v55, 0xffff0000, v137
    v_lshlrev_b32 v56, 16, v146
    v_and_b32 v57, 0xffff0000, v146
    v_lshlrev_b32 v58, 16, v147
    v_and_b32 v59, 0xffff0000, v147
    v_lshlrev_b32 v60, 16, v156
    v_and_b32 v61, 0xffff0000, v156
    v_lshlrev_b32 v62, 16, v157
    v_and_b32 v63, 0xffff0000, v157
    v_lshlrev_b32 v172, 16, v172
    v_mul_f32 v56, v56, v60
    v_lshlrev_b32 v173, 16, v173
    v_mul_f32 v57, v57, v61
    v_lshlrev_b32 v174, 16, v174
    v_mul_f32 v58, v58, v62
    v_lshlrev_b32 v175, 16, v175
    v_mul_f32 v59, v59, v63
    v_cvt_pk_bf16_f32 v64, v56, v57
    v_cvt_pk_bf16_f32 v65, v58, v59
    v_lshlrev_b32 v56, 16, v64
    v_and_b32 v57, 0xffff0000, v64
    v_lshlrev_b32 v58, 16, v65
    v_and_b32 v59, 0xffff0000, v65
    v_add_f32 v56, v56, v172
    v_add_f32 v57, v57, v173
    v_add_f32 v58, v58, v174
    v_add_f32 v59, v59, v175
    v_cvt_pk_bf16_f32 v64, v56, v57
    v_cvt_pk_bf16_f32 v65, v58, v59
    v_lshlrev_b32 v56, 16, v64
    v_and_b32 v57, 0xffff0000, v64
    v_lshlrev_b32 v58, 16, v65
    v_and_b32 v59, 0xffff0000, v65
    v_add_f32 v56, v56, v52
    v_add_f32 v57, v57, v53
    v_add_f32 v58, v58, v54
    v_add_f32 v59, v59, v55
    v_cvt_pk_bf16_f32 v64, v56, v57
    v_cvt_pk_bf16_f32 v65, v58, v59
    v_lshlrev_b32 v56, 16, v64
    v_and_b32 v57, 0xffff0000, v64
    v_lshlrev_b32 v58, 16, v65
    v_and_b32 v59, 0xffff0000, v65
    s_waitcnt lgkmcnt(2)
    v_add_f32 v28, v28, v32
    v_add_f32 v29, v29, v33
    v_add_f32 v30, v30, v34
    v_add_f32 v31, v31, v35
    v_cvt_pk_bf16_f32 v64, v28, v29
    v_cvt_pk_bf16_f32 v65, v30, v31
    v_lshlrev_b32 v28, 16, v64
    v_and_b32 v29, 0xffff0000, v64
    v_lshlrev_b32 v30, 16, v65
    v_and_b32 v31, 0xffff0000, v65
    v_add_f32 v56, v56, v28
    v_add_f32 v57, v57, v29
    v_add_f32 v58, v58, v30
    v_add_f32 v59, v59, v31
    v_cvt_pk_bf16_f32 v84, v56, v57
    v_cvt_pk_bf16_f32 v85, v58, v59
    global_store_dwordx2 v8, v[84:85], s[30:31] offset:64 sc0 sc1
    v_lshlrev_b32 v52, 16, v138
    v_and_b32 v53, 0xffff0000, v138
    v_lshlrev_b32 v54, 16, v139
    v_and_b32 v55, 0xffff0000, v139
    v_lshlrev_b32 v56, 16, v148
    v_and_b32 v57, 0xffff0000, v148
    v_lshlrev_b32 v58, 16, v149
    v_and_b32 v59, 0xffff0000, v149
    v_lshlrev_b32 v60, 16, v158
    v_and_b32 v61, 0xffff0000, v158
    v_lshlrev_b32 v62, 16, v159
    v_and_b32 v63, 0xffff0000, v159
    v_lshlrev_b32 v176, 16, v176
    v_mul_f32 v56, v56, v60
    v_lshlrev_b32 v177, 16, v177
    v_mul_f32 v57, v57, v61
    v_lshlrev_b32 v178, 16, v178
    v_mul_f32 v58, v58, v62
    v_lshlrev_b32 v179, 16, v179
    v_mul_f32 v59, v59, v63
    v_cvt_pk_bf16_f32 v64, v56, v57
    v_cvt_pk_bf16_f32 v65, v58, v59
    v_lshlrev_b32 v56, 16, v64
    v_and_b32 v57, 0xffff0000, v64
    v_lshlrev_b32 v58, 16, v65
    v_and_b32 v59, 0xffff0000, v65
    v_add_f32 v56, v56, v176
    v_add_f32 v57, v57, v177
    v_add_f32 v58, v58, v178
    v_add_f32 v59, v59, v179
    v_cvt_pk_bf16_f32 v64, v56, v57
    v_cvt_pk_bf16_f32 v65, v58, v59
    v_lshlrev_b32 v56, 16, v64
    v_and_b32 v57, 0xffff0000, v64
    v_lshlrev_b32 v58, 16, v65
    v_and_b32 v59, 0xffff0000, v65
    v_add_f32 v56, v56, v52
    v_add_f32 v57, v57, v53
    v_add_f32 v58, v58, v54
    v_add_f32 v59, v59, v55
    v_cvt_pk_bf16_f32 v64, v56, v57
    v_cvt_pk_bf16_f32 v65, v58, v59
    v_lshlrev_b32 v56, 16, v64
    v_and_b32 v57, 0xffff0000, v64
    v_lshlrev_b32 v58, 16, v65
    v_and_b32 v59, 0xffff0000, v65
    s_waitcnt lgkmcnt(1)
    v_add_f32 v36, v36, v40
    v_add_f32 v37, v37, v41
    v_add_f32 v38, v38, v42
    v_add_f32 v39, v39, v43
    v_cvt_pk_bf16_f32 v64, v36, v37
    v_cvt_pk_bf16_f32 v65, v38, v39
    v_lshlrev_b32 v36, 16, v64
    v_and_b32 v37, 0xffff0000, v64
    v_lshlrev_b32 v38, 16, v65
    v_and_b32 v39, 0xffff0000, v65
    v_add_f32 v56, v56, v36
    v_add_f32 v57, v57, v37
    v_add_f32 v58, v58, v38
    v_add_f32 v59, v59, v39
    v_cvt_pk_bf16_f32 v86, v56, v57
    v_cvt_pk_bf16_f32 v87, v58, v59
    global_store_dwordx2 v8, v[86:87], s[30:31] offset:96 sc0 sc1
    v_lshlrev_b32 v52, 16, v140
    v_and_b32 v53, 0xffff0000, v140
    v_lshlrev_b32 v54, 16, v141
    v_and_b32 v55, 0xffff0000, v141
    v_lshlrev_b32 v56, 16, v150
    v_and_b32 v57, 0xffff0000, v150
    v_lshlrev_b32 v58, 16, v151
    v_and_b32 v59, 0xffff0000, v151
    v_lshlrev_b32 v60, 16, v160
    v_and_b32 v61, 0xffff0000, v160
    v_lshlrev_b32 v62, 16, v161
    v_and_b32 v63, 0xffff0000, v161
    v_lshlrev_b32 v180, 16, v180
    v_mul_f32 v56, v56, v60
    v_lshlrev_b32 v181, 16, v181
    v_mul_f32 v57, v57, v61
    v_lshlrev_b32 v182, 16, v182
    v_mul_f32 v58, v58, v62
    v_lshlrev_b32 v183, 16, v183
    v_mul_f32 v59, v59, v63
    v_cvt_pk_bf16_f32 v64, v56, v57
    v_cvt_pk_bf16_f32 v65, v58, v59
    v_lshlrev_b32 v56, 16, v64
    v_and_b32 v57, 0xffff0000, v64
    v_lshlrev_b32 v58, 16, v65
    v_and_b32 v59, 0xffff0000, v65
    v_add_f32 v56, v56, v180
    v_add_f32 v57, v57, v181
    v_add_f32 v58, v58, v182
    v_add_f32 v59, v59, v183
    v_cvt_pk_bf16_f32 v64, v56, v57
    v_cvt_pk_bf16_f32 v65, v58, v59
    v_lshlrev_b32 v56, 16, v64
    v_and_b32 v57, 0xffff0000, v64
    v_lshlrev_b32 v58, 16, v65
    v_and_b32 v59, 0xffff0000, v65
    v_add_f32 v56, v56, v52
    v_add_f32 v57, v57, v53
    v_add_f32 v58, v58, v54
    v_add_f32 v59, v59, v55
    v_cvt_pk_bf16_f32 v64, v56, v57
    v_cvt_pk_bf16_f32 v65, v58, v59
    v_lshlrev_b32 v56, 16, v64
    v_and_b32 v57, 0xffff0000, v64
    v_lshlrev_b32 v58, 16, v65
    v_and_b32 v59, 0xffff0000, v65
    s_waitcnt lgkmcnt(0)
    v_add_f32 v44, v44, v48
    v_add_f32 v45, v45, v49
    v_add_f32 v46, v46, v50
    v_add_f32 v47, v47, v51
    v_cvt_pk_bf16_f32 v64, v44, v45
    v_cvt_pk_bf16_f32 v65, v46, v47
    v_lshlrev_b32 v44, 16, v64
    v_and_b32 v45, 0xffff0000, v64
    v_lshlrev_b32 v46, 16, v65
    v_and_b32 v47, 0xffff0000, v65
    v_add_f32 v56, v56, v44
    v_add_f32 v57, v57, v45
    v_add_f32 v58, v58, v46
    v_add_f32 v59, v59, v47
    v_cvt_pk_bf16_f32 v88, v56, v57
    v_cvt_pk_bf16_f32 v89, v58, v59
    global_store_dwordx2 v8, v[88:89], s[30:31] offset:128 sc0 sc1
L_end_p3:
    s_endpgm
.section .rodata,"a"
.p2align 6
.amdhsa_kernel prep_kernel
  .amdhsa_next_free_vgpr 128
  .amdhsa_next_free_sgpr 96
  .amdhsa_accum_offset 128
  .amdhsa_group_segment_fixed_size 0
  .amdhsa_kernarg_size 112
  .amdhsa_user_sgpr_count 2
  .amdhsa_user_sgpr_kernarg_segment_ptr 1
  .amdhsa_system_sgpr_workgroup_id_x 1
.end_amdhsa_kernel

.p2align 6
.amdhsa_kernel mid_kernel
  .amdhsa_next_free_vgpr 168
  .amdhsa_next_free_sgpr 96
  .amdhsa_accum_offset 168
  .amdhsa_group_segment_fixed_size 0
  .amdhsa_kernarg_size 112
  .amdhsa_user_sgpr_count 2
  .amdhsa_user_sgpr_kernarg_segment_ptr 1
  .amdhsa_system_sgpr_workgroup_id_x 1
.end_amdhsa_kernel

.p2align 6
.amdhsa_kernel fin_kernel
  .amdhsa_next_free_vgpr 184
  .amdhsa_next_free_sgpr 96
  .amdhsa_accum_offset 184
  .amdhsa_group_segment_fixed_size 0
  .amdhsa_kernarg_size 112
  .amdhsa_user_sgpr_count 2
  .amdhsa_user_sgpr_kernarg_segment_ptr 1
  .amdhsa_system_sgpr_workgroup_id_x 1
.end_amdhsa_kernel
```
